```python
import torch

def _softmax(x, axis=-1):
    return torch.softmax(x, dim=axis)
def _gelu(x):
    return torch.nn.functional.gelu(x, approximate="tanh")
def _silu(x):
    return torch.nn.functional.silu(x)
def _sigmoid(x):
    return torch.sigmoid(x)
def _layernorm(x, axis=-1, eps=1e-5):
    m = x.mean(dim=axis, keepdim=True)
    v = x.var(dim=axis, keepdim=True, unbiased=False)
    return (x - m) / torch.sqrt(v + eps)
def _scatter_add(tgt, idx, src, axis=0):
    return tgt.clone().index_add_(axis, idx, src)
def _segment_sum(src, seg, n):
    out = torch.zeros((n,) + src.shape[1:], dtype=src.dtype)
    return out.index_add_(0, seg, src)
def _pad(x, pw):
    flat = tuple(v for pair in reversed(pw) for v in pair)
    return torch.nn.functional.pad(x, flat)

kernel_name = 'recurrent_scan__gqa_block_cached__glu_gated_swiglu__decode'

def setup_inputs():

    _w = (lambda a: (lambda t: t.to(torch.bfloat16) if t.is_floating_point() else t)(torch.as_tensor(a)))
    def _A_setup():
        B, Sq, D = 4, 1, 512
        Hq, Hkv, Sk, Dh = 32, 8, 4096, 128
        assert Hq % Hkv == 0, (Hq, Hkv)
        return {
            "x": _w((lambda *s: torch.randn(*s, dtype=torch.bfloat16) * 0.05)(B, Sq, D)),
            "k_cache": _w((lambda *s: torch.randn(*s, dtype=torch.bfloat16) * 3.2)(B, Hkv, Sk, Dh)),
            "v_cache": _w((lambda *s: torch.randn(*s, dtype=torch.bfloat16) * 3.2)(B, Hkv, Sk, Dh)),
            "wq": _w((lambda *s: torch.randn(*s, dtype=torch.bfloat16) * 3.2)(D, Hq * Dh) * (D ** -0.5)),
            "wo": _w((lambda *s: torch.randn(*s, dtype=torch.bfloat16) * 3.2)(Hq * Dh, D) * ((Hq * Dh) ** -0.5)),
        }
    _A_in = _A_setup()

    def _B_setup():
        B, S, D, F = 4, 1, 512, 1792
        return {
            "x": _w((lambda *s: torch.randn(*s, dtype=torch.bfloat16) * 0.05)(B, S, D)),
            "w1": _w((lambda *s: torch.randn(*s, dtype=torch.bfloat16) * 0.4)(D, F) * (2.0 / D) ** 0.5),
            "w3": _w((lambda *s: torch.randn(*s, dtype=torch.bfloat16) * 0.4)(D, F) * (2.0 / D) ** 0.5),
            "w2": _w((lambda *s: torch.randn(*s, dtype=torch.bfloat16) * 0.4)(F, D) * (2.0 / F) ** 0.5),
        }
    _B_in = _B_setup()

    return {
        "A_x": _A_in["x"],
        "A_k_cache": _A_in["k_cache"],
        "A_v_cache": _A_in["v_cache"],
        "A_wq": _A_in["wq"],
        "A_wo": _A_in["wo"],
        "B_x": _B_in["x"],
        "B_w1": _B_in["w1"],
        "B_w3": _B_in["w3"],
        "B_w2": _B_in["w2"],
    }

def reference(A_x, A_k_cache, A_v_cache, A_wq, A_wo, B_x, B_w1, B_w3, B_w2):
    def _A_ref(x, k_cache, v_cache, wq, wo):
        B, Sq, D = x.shape
        Hq, Dh = 32, 128
        Hkv = k_cache.shape[1]
        rep = Hq // Hkv
        q = (lambda x, *d: x.permute(*d))((x @ wq).reshape(B, Sq, Hq, Dh), 0, 2, 1, 3)
        k = (lambda x, n, axis: torch.repeat_interleave(x, n, dim=axis))(k_cache, rep, axis=1)
        v = (lambda x, n, axis: torch.repeat_interleave(x, n, dim=axis))(v_cache, rep, axis=1)
        scores = torch.einsum("bhqd,bhkd->bhqk", q, k) * (Dh ** -0.5)
        p = _softmax(scores, axis=-1)
        o = torch.einsum("bhqk,bhkd->bhqd", p, v)
        return (lambda x, *d: x.permute(*d))(o, 0, 2, 1, 3).reshape(B, Sq, Hq * Dh) @ wo

    def _B_ref(x, w1, w3, w2):
        gate = torch.einsum("bsd,df->bsf", x, w1)
        up = torch.einsum("bsd,df->bsf", x, w3)
        h = _silu(gate) * up
        out = torch.einsum("bsf,fd->bsd", h, w2)
        return out

    x = A_x
    xn = _layernorm(x, axis=-1)
    s = _A_ref(xn, A_k_cache, A_v_cache, A_wq, A_wo)
    g = _silu(_B_ref(xn, B_w1, B_w3, B_w2))
    return x + s * g
```

```asm
; @launch grid=(256,1,1) block=(768,1,1) lds=81920
.amdgcn_target "amdgcn-amd-amdhsa--gfx950"
.text
.globl recurrent_scan__gqa_block_cached__glu_gated_swiglu__decode_kernel
.p2align 8
.type recurrent_scan__gqa_block_cached__glu_gated_swiglu__decode_kernel,@function
recurrent_scan__gqa_block_cached__glu_gated_swiglu__decode_kernel:
    s_cmp_ge_u32 s2, 256
    s_cbranch_scc1 L_end

    s_load_dwordx16 s[4:19], s[0:1], 0
    s_load_dwordx8 s[20:27], s[0:1], 64
    v_lshrrev_b32 v1, 6, v0
    v_and_b32 v0, 63, v0
    v_readfirstlane_b32 s3, v1
    s_and_b32 s28, s2, 7
    s_lshr_b32 s29, s2, 3
    s_add_u32 s3, s3, 8
    s_cmp_ge_u32 s3, 12
    s_cselect_b32 s50, 12, 0
    s_sub_u32 s3, s3, s50
    s_cmp_ge_u32 s3, 8
    s_cbranch_scc0 L_swave
L_helper:
    s_cmp_lg_u32 s3, 8
    s_cbranch_scc1 L_noclr
    v_mov_b32 v2, 0
    v_lshlrev_b32 v1, 2, v0
    s_mov_b64 exec, 0xffff
    ds_write_b32 v1, v2 offset:0
    s_mov_b64 exec, -1
L_noclr:
    s_and_b32 s50, s28, 3
    s_lshr_b32 s51, s28, 2
    s_lshl_b32 s67, s50, 1
    s_lshr_b32 s52, s29, 4
    s_add_u32 s67, s67, s52
    s_lshl_b32 s52, s51, 2
    s_add_u32 s67, s67, s52
    s_add_u32 s67, s67, 2
    s_and_b32 s67, s67, 7
    s_and_b32 s52, s29, 1
    s_lshl1_add_u32 s52, s51, s52
    s_bfe_u32 s100, s29, 0x30001
    s_lshl2_add_u32 s100, s100, s52
    s_mul_i32 s48, s50, 28
    s_add_u32 s48, s48, s29
    s_lshr_b32 s48, s48, 1
    s_lshl2_add_u32 s48, s48, s52
    s_lshl_b32 s101, s50, 3
    s_add_u32 s101, s101, s29
    s_xor_b32 s52, s52, 2
    s_lshl_b32 s52, s52, 4
    s_bfe_u32 s69, s101, 0x30001
    s_lshl1_add_u32 s52, s69, s52
    s_lshr_b32 s101, s101, 4
    s_add_u32 s101, s101, s52
    s_mul_i32 s52, s29, 37
    s_lshr_b32 s52, s52, 8
    s_mul_i32 s69, s52, 7
    s_sub_u32 s69, s29, s69
    s_add_u32 s50, s50, 1
    s_and_b32 s50, s50, 3
    s_mul_i32 s50, s50, 7
    s_add_u32 s69, s69, s50
    s_lshl_b32 s69, s69, 3
    s_lshl2_add_u32 s52, s51, s52
    s_add_u32 s69, s69, s52
    s_add_u32 s68, s28, 4
    s_and_b32 s68, s68, 7
    s_setprio 3
    s_sub_u32 s65, s3, 8
    v_mov_b32 v5, 0
    v_mov_b32 v6, 1
    v_lshlrev_b32 v1, 4, v0
    s_lshl_b32 s50, s65, 10
    v_add_u32 v1, s50, v1
    v_bfe_u32 v13, v0, 2, 2
    v_and_b32 v14, 3, v0
    v_lshlrev_b32 v14, 4, v14
    v_lshrrev_b32 v7, 5, v0
    v_lshl_add_u32 v2, v7, 2, v13
    v_bfe_u32 v7, v0, 4, 1
    v_lshl_add_u32 v12, v7, 6, v14
    v_lshrrev_b32 v7, 4, v0
    v_lshl_add_u32 v3, v7, 6, v14
    v_lshl_add_u32 v3, v13, 10, v3
    s_waitcnt lgkmcnt(0)
    s_mov_b32 s44, s4
    s_mov_b32 s45, s5
    s_mov_b32 s46, 4096
    s_mov_b32 s47, 0x00020000
    buffer_load_dwordx4 v[8:11], v1, s[44:47], 0 offen
    s_mov_b32 s32, s26
    s_mov_b32 s33, s27
    s_mov_b32 s34, 8388608
    s_mov_b32 s35, 0x00020000
    s_load_dword s30, s[26:27], 0
    s_cmp_eq_u32 s65, 0
    s_cbranch_scc1 L_h0a
    s_cmp_ge_u32 s65, 2
    s_cbranch_scc1 L_h2a
    s_cmp_ge_u32 s29, 28
    s_cbranch_scc1 L_h2a
    s_mov_b32 s36, s16
    s_mov_b32 s37, s17
    s_mov_b32 s38, 1835008
    s_mov_b32 s39, 0x00020000
    s_mov_b32 s40, s18
    s_mov_b32 s41, s19
    s_mov_b32 s42, 1835008
    s_mov_b32 s43, 0x00020000
    s_movk_i32 s51, 3584
    v_mul_lo_u32 v1, v2, s51
    v_add_u32 v1, v12, v1
    s_and_b32 s50, s69, 7
    s_mul_i32 s50, s50, 229376
    s_lshr_b32 s51, s69, 3
    s_lshl_b32 s51, s51, 7
    s_add_u32 s50, s50, s51
    s_mov_b32 s53, s50
    s_mov_b32 m0, 18944
    s_nop 0
    buffer_load_dwordx4 v1, s[36:39], s50 offen nt lds
    s_mov_b32 m0, 20000
    s_add_u32 s50, s50, 28672
    buffer_load_dwordx4 v1, s[36:39], s50 offen nt lds
    s_mov_b32 m0, 21056
    s_add_u32 s50, s50, 28672
    buffer_load_dwordx4 v1, s[36:39], s50 offen nt lds
    s_mov_b32 m0, 22112
    s_add_u32 s50, s50, 28672
    buffer_load_dwordx4 v1, s[36:39], s50 offen nt lds
    s_mov_b32 m0, 23168
    s_add_u32 s50, s50, 28672
    buffer_load_dwordx4 v1, s[36:39], s50 offen nt lds
    s_mov_b32 m0, 24224
    s_add_u32 s50, s50, 28672
    buffer_load_dwordx4 v1, s[36:39], s50 offen nt lds
    s_mov_b32 m0, 25280
    s_add_u32 s50, s50, 28672
    buffer_load_dwordx4 v1, s[36:39], s50 offen nt lds
    s_mov_b32 m0, 26336
    s_add_u32 s50, s50, 28672
    buffer_load_dwordx4 v1, s[36:39], s50 offen nt lds
    s_mov_b32 m0, 27392
    s_nop 0
    buffer_load_dwordx4 v1, s[40:43], s53 offen nt lds
    s_mov_b32 m0, 28448
    s_add_u32 s53, s53, 28672
    buffer_load_dwordx4 v1, s[40:43], s53 offen nt lds
    s_mov_b32 m0, 29504
    s_add_u32 s53, s53, 28672
    buffer_load_dwordx4 v1, s[40:43], s53 offen nt lds
    s_mov_b32 m0, 30560
    s_add_u32 s53, s53, 28672
    buffer_load_dwordx4 v1, s[40:43], s53 offen nt lds
    s_mov_b32 m0, 31616
    s_add_u32 s53, s53, 28672
    buffer_load_dwordx4 v1, s[40:43], s53 offen nt lds
    s_mov_b32 m0, 32672
    s_add_u32 s53, s53, 28672
    buffer_load_dwordx4 v1, s[40:43], s53 offen nt lds
    s_mov_b32 m0, 33728
    s_add_u32 s53, s53, 28672
    buffer_load_dwordx4 v1, s[40:43], s53 offen nt lds
    s_mov_b32 m0, 34784
    s_add_u32 s53, s53, 28672
    buffer_load_dwordx4 v1, s[40:43], s53 offen nt lds
    s_barrier
    s_waitcnt vmcnt(16)
    s_branch L_ln
L_h0a:
    s_mov_b32 s36, s10
    s_mov_b32 s37, s11
    s_mov_b32 s38, 4194304
    s_mov_b32 s39, 0x00020000
    v_lshl_add_u32 v1, v2, 13, v12
    s_and_b32 s50, s29, 3
    s_lshl_b32 s50, s50, 20
    s_lshl_b32 s51, s68, 10
    s_add_u32 s50, s50, s51
    s_lshr_b32 s51, s29, 2
    s_lshl_b32 s51, s51, 7
    s_add_u32 s50, s50, s51
    s_mov_b32 m0, 2048
    s_nop 0
    buffer_load_dwordx4 v1, s[36:39], s50 offen nt lds
    s_mov_b32 m0, 3104
    s_add_u32 s50, s50, 65536
    buffer_load_dwordx4 v1, s[36:39], s50 offen nt lds
    s_mov_b32 m0, 4160
    s_add_u32 s50, s50, 65536
    buffer_load_dwordx4 v1, s[36:39], s50 offen nt lds
    s_mov_b32 m0, 5216
    s_add_u32 s50, s50, 65536
    buffer_load_dwordx4 v1, s[36:39], s50 offen nt lds
    s_mov_b32 m0, 6272
    s_add_u32 s50, s50, 65536
    buffer_load_dwordx4 v1, s[36:39], s50 offen nt lds
    s_mov_b32 m0, 7328
    s_add_u32 s50, s50, 65536
    buffer_load_dwordx4 v1, s[36:39], s50 offen nt lds
    s_mov_b32 m0, 8384
    s_add_u32 s50, s50, 65536
    buffer_load_dwordx4 v1, s[36:39], s50 offen nt lds
    s_mov_b32 m0, 9440
    s_add_u32 s50, s50, 65536
    buffer_load_dwordx4 v1, s[36:39], s50 offen nt lds
    s_mov_b32 m0, 10496
    s_add_u32 s50, s50, 65536
    buffer_load_dwordx4 v1, s[36:39], s50 offen nt lds
    s_mov_b32 m0, 11552
    s_add_u32 s50, s50, 65536
    buffer_load_dwordx4 v1, s[36:39], s50 offen nt lds
    s_mov_b32 m0, 12608
    s_add_u32 s50, s50, 65536
    buffer_load_dwordx4 v1, s[36:39], s50 offen nt lds
    s_mov_b32 m0, 13664
    s_add_u32 s50, s50, 65536
    buffer_load_dwordx4 v1, s[36:39], s50 offen nt lds
    s_mov_b32 m0, 14720
    s_add_u32 s50, s50, 65536
    buffer_load_dwordx4 v1, s[36:39], s50 offen nt lds
    s_mov_b32 m0, 15776
    s_add_u32 s50, s50, 65536
    buffer_load_dwordx4 v1, s[36:39], s50 offen nt lds
    s_mov_b32 m0, 16832
    s_add_u32 s50, s50, 65536
    buffer_load_dwordx4 v1, s[36:39], s50 offen nt lds
    s_mov_b32 m0, 17888
    s_add_u32 s50, s50, 65536
    buffer_load_dwordx4 v1, s[36:39], s50 offen nt lds
    s_barrier
    s_waitcnt vmcnt(16)
    s_branch L_ln
L_h2a:
    s_barrier
    s_waitcnt vmcnt(0)
L_ln:
    v_lshlrev_b32 v12, 16, v8
    v_and_b32 v13, 0xffff0000, v8
    v_lshlrev_b32 v14, 16, v9
    v_and_b32 v15, 0xffff0000, v9
    v_lshlrev_b32 v16, 16, v10
    v_and_b32 v17, 0xffff0000, v10
    v_lshlrev_b32 v18, 16, v11
    v_and_b32 v19, 0xffff0000, v11
    v_add_f32 v20, v12, v13
    v_add_f32 v21, v14, v15
    v_add_f32 v22, v16, v17
    v_add_f32 v23, v18, v19
    v_add_f32 v20, v20, v21
    v_add_f32 v22, v22, v23
    v_add_f32 v20, v20, v22
    s_nop 1
    v_add_f32_dpp v20, v20, v20 quad_perm:[1,0,3,2] row_mask:0xf bank_mask:0xf
    s_nop 1
    v_add_f32_dpp v20, v20, v20 quad_perm:[2,3,0,1] row_mask:0xf bank_mask:0xf
    s_nop 1
    v_add_f32_dpp v20, v20, v20 row_half_mirror row_mask:0xf bank_mask:0xf
    s_nop 1
    v_add_f32_dpp v20, v20, v20 row_mirror row_mask:0xf bank_mask:0xf
    v_mov_b32 v7, v20
    s_nop 1
    v_permlane32_swap_b32 v20, v7
    v_add_f32 v20, v20, v7
    v_mov_b32 v7, v20
    s_nop 1
    v_permlane16_swap_b32 v20, v7
    v_add_f32 v20, v20, v7
    v_mul_f32 v20, 0x3b000000, v20
    v_sub_f32 v24, v12, v20
    v_sub_f32 v25, v13, v20
    v_sub_f32 v26, v14, v20
    v_sub_f32 v27, v15, v20
    v_sub_f32 v28, v16, v20
    v_sub_f32 v29, v17, v20
    v_sub_f32 v30, v18, v20
    v_sub_f32 v31, v19, v20
    v_mul_f32 v21, v24, v24
    v_mul_f32 v22, v25, v25
    v_fmac_f32 v21, v26, v26
    v_fmac_f32 v22, v27, v27
    v_fmac_f32 v21, v28, v28
    v_fmac_f32 v22, v29, v29
    v_fmac_f32 v21, v30, v30
    v_fmac_f32 v22, v31, v31
    v_add_f32 v21, v21, v22
    s_nop 1
    v_add_f32_dpp v21, v21, v21 quad_perm:[1,0,3,2] row_mask:0xf bank_mask:0xf
    s_nop 1
    v_add_f32_dpp v21, v21, v21 quad_perm:[2,3,0,1] row_mask:0xf bank_mask:0xf
    s_nop 1
    v_add_f32_dpp v21, v21, v21 row_half_mirror row_mask:0xf bank_mask:0xf
    s_nop 1
    v_add_f32_dpp v21, v21, v21 row_mirror row_mask:0xf bank_mask:0xf
    v_mov_b32 v7, v21
    s_nop 1
    v_permlane32_swap_b32 v21, v7
    v_add_f32 v21, v21, v7
    v_mov_b32 v7, v21
    s_nop 1
    v_permlane16_swap_b32 v21, v7
    v_add_f32 v21, v21, v7
    v_mul_f32 v21, 0x3b000000, v21
    v_cvt_pk_bf16_f32 v7, v20, v21
    v_lshlrev_b32 v20, 16, v7
    v_and_b32 v21, 0xffff0000, v7
    v_add_f32 v21, 0x3727c5ac, v21
    v_cvt_pk_bf16_f32 v21, v21, v21
    v_and_b32 v21, 0xffff0000, v21
    v_sqrt_f32 v21, v21
    s_nop 0
    v_cvt_pk_bf16_f32 v21, v21, v21
    v_and_b32 v21, 0xffff0000, v21
    v_rcp_f32 v22, v21
    v_sub_f32 v12, v12, v20
    v_sub_f32 v13, v13, v20
    v_sub_f32 v14, v14, v20
    v_sub_f32 v15, v15, v20
    v_sub_f32 v16, v16, v20
    v_sub_f32 v17, v17, v20
    v_sub_f32 v18, v18, v20
    v_sub_f32 v19, v19, v20
    v_cvt_pk_bf16_f32 v7, v12, v13
    v_lshlrev_b32 v12, 16, v7
    v_and_b32 v13, 0xffff0000, v7
    v_cvt_pk_bf16_f32 v7, v14, v15
    v_lshlrev_b32 v14, 16, v7
    v_and_b32 v15, 0xffff0000, v7
    v_cvt_pk_bf16_f32 v7, v16, v17
    v_lshlrev_b32 v16, 16, v7
    v_and_b32 v17, 0xffff0000, v7
    v_cvt_pk_bf16_f32 v7, v18, v19
    v_lshlrev_b32 v18, 16, v7
    v_and_b32 v19, 0xffff0000, v7
    v_mul_f32 v24, v12, v22
    v_mul_f32 v25, v13, v22
    v_mul_f32 v26, v14, v22
    v_mul_f32 v27, v15, v22
    v_mul_f32 v28, v16, v22
    v_mul_f32 v29, v17, v22
    v_mul_f32 v30, v18, v22
    v_mul_f32 v31, v19, v22
    v_fma_f32 v12, -v24, v21, v12
    v_fma_f32 v13, -v25, v21, v13
    v_fma_f32 v14, -v26, v21, v14
    v_fma_f32 v15, -v27, v21, v15
    v_fma_f32 v16, -v28, v21, v16
    v_fma_f32 v17, -v29, v21, v17
    v_fma_f32 v18, -v30, v21, v18
    v_fma_f32 v19, -v31, v21, v19
    v_fmac_f32 v24, v12, v22
    v_fmac_f32 v25, v13, v22
    v_fmac_f32 v26, v14, v22
    v_fmac_f32 v27, v15, v22
    v_fmac_f32 v28, v16, v22
    v_fmac_f32 v29, v17, v22
    v_fmac_f32 v30, v18, v22
    v_fmac_f32 v31, v19, v22
    v_cvt_pk_bf16_f32 v8, v24, v25
    v_cvt_pk_bf16_f32 v9, v26, v27
    v_cvt_pk_bf16_f32 v10, v28, v29
    v_cvt_pk_bf16_f32 v11, v30, v31
    s_mul_i32 s50, s65, 1088
    v_lshlrev_b32 v1, 4, v0
    v_add_u32 v1, s50, v1
    ds_write_b128 v1, v[8:11] offset:60800
    s_mov_b64 exec, 1
    ds_add_u32 v5, v6 offset:0
    s_mov_b64 exec, -1
    s_waitcnt lgkmcnt(0)
    s_add_u32 s30, s30, 1
    s_and_b32 s31, s30, 0xfff
    v_and_b32 v8, 3, v0
    v_lshrrev_b32 v9, 4, v0
    v_bfe_u32 v10, v0, 2, 2
    v_mov_b32 v4, s31
    s_mov_b32 s66, 0xfff
    s_mov_b32 s94, 0x00f000f0
    s_mov_b32 s95, 0x00f000f0
    s_mov_b32 s96, 0x0f000f00
    s_mov_b32 s97, 0x0f000f00
    s_mov_b32 s98, 0xf000f000
    s_mov_b32 s99, 0xf000f000
    v_lshlrev_b32 v7, 3, v8
    v_lshl_add_u32 v7, v10, 6, v7
    s_movk_i32 s50, 2080
    v_mad_u32_u24 v13, v9, s50, v7
    s_movk_i32 s50, 1056
    v_mad_u32_u24 v12, v9, s50, v7
    s_movk_i32 s50, 1088
    v_mul_u32_u24 v14, s50, v8
    v_lshl_add_u32 v14, v9, 4, v14
    s_cmp_eq_u32 s65, 2
    s_cbranch_scc1 L_h2b
    s_cmp_eq_u32 s65, 3
    s_cbranch_scc1 L_h3b
    s_cmp_eq_u32 s65, 0
    s_cbranch_scc1 L_h0b
    s_cmp_ge_u32 s29, 28
    s_cbranch_scc1 L_wo
    s_waitcnt vmcnt(0)
    ds_read_b64_tr_b16 v[16:17], v12 offset:18944
    ds_read_b64_tr_b16 v[18:19], v12 offset:19456
    ds_read_b64_tr_b16 v[20:21], v12 offset:18976
    ds_read_b64_tr_b16 v[22:23], v12 offset:19488
    ds_read_b64_tr_b16 v[24:25], v12 offset:19200
    ds_read_b64_tr_b16 v[26:27], v12 offset:19712
    ds_read_b64_tr_b16 v[28:29], v12 offset:19232
    ds_read_b64_tr_b16 v[30:31], v12 offset:19744
    ds_read_b64_tr_b16 v[32:33], v12 offset:23168
    ds_read_b64_tr_b16 v[34:35], v12 offset:23680
    ds_read_b64_tr_b16 v[36:37], v12 offset:23200
    ds_read_b64_tr_b16 v[38:39], v12 offset:23712
    ds_read_b64_tr_b16 v[40:41], v12 offset:23424
    ds_read_b64_tr_b16 v[42:43], v12 offset:23936
    ds_read_b64_tr_b16 v[44:45], v12 offset:23456
    ds_read_b64_tr_b16 v[46:47], v12 offset:23968
    ds_read_b64_tr_b16 v[48:49], v12 offset:27392
    ds_read_b64_tr_b16 v[50:51], v12 offset:27904
    ds_read_b64_tr_b16 v[52:53], v12 offset:27424
    ds_read_b64_tr_b16 v[54:55], v12 offset:27936
    ds_read_b64_tr_b16 v[56:57], v12 offset:27648
    ds_read_b64_tr_b16 v[58:59], v12 offset:28160
    ds_read_b64_tr_b16 v[60:61], v12 offset:27680
    ds_read_b64_tr_b16 v[62:63], v12 offset:28192
    ds_read_b64_tr_b16 v[64:65], v12 offset:31616
    ds_read_b64_tr_b16 v[66:67], v12 offset:32128
    ds_read_b64_tr_b16 v[68:69], v12 offset:31648
    ds_read_b64_tr_b16 v[70:71], v12 offset:32160
    ds_read_b64_tr_b16 v[72:73], v12 offset:31872
    ds_read_b64_tr_b16 v[74:75], v12 offset:32384
    ds_read_b64_tr_b16 v[76:77], v12 offset:31904
    ds_read_b64_tr_b16 v[78:79], v12 offset:32416
    s_and_b32 s50, s69, 7
    s_lshl_b32 s50, s50, 7
    v_add_u32 v14, s50, v14
    v_lshrrev_b32 v7, 1, v10
    v_lshlrev_b32 v1, 13, v7
    v_and_b32 v7, 1, v10
    v_lshl_add_u32 v1, v7, 9, v1
    v_lshrrev_b32 v7, 1, v9
    v_lshl_add_u32 v1, v7, 8, v1
    v_and_b32 v7, 1, v9
    v_lshl_add_u32 v1, v7, 6, v1
    v_lshl_add_u32 v1, v8, 4, v1
    s_lshr_b32 s50, s69, 3
    s_lshl_b32 s50, s50, 14
    s_bfe_u32 s51, s69, 0x20001
    s_lshl_b32 s51, s51, 11
    s_add_u32 s50, s50, s51
    s_and_b32 s51, s69, 1
    s_lshl_b32 s51, s51, 7
    s_add_u32 s50, s50, s51
    s_add_u32 s50, s50, 524288
    s_mov_b32 s64, 262144
L_spin_1:
    ds_read_b32 v7, v5 offset:0
    s_waitcnt lgkmcnt(0)
    v_cmp_le_u32 vcc, 4, v7
    s_cbranch_vccnz L_spun_2
    s_sub_u32 s64, s64, 1
    s_cmp_lg_u32 s64, 0
    s_cbranch_scc1 L_spin_1
L_spun_2:
    ds_read_b128 v[80:83], v14 offset:60800
    ds_read_b128 v[84:87], v14 offset:60864
    s_waitcnt lgkmcnt(0)
    v_mfma_f32_16x16x32_bf16 v[96:99], v[16:19], v[80:83], 0
    v_mfma_f32_16x16x32_bf16 v[100:103], v[20:23], v[80:83], 0
    v_mfma_f32_16x16x32_bf16 v[104:107], v[24:27], v[80:83], 0
    v_mfma_f32_16x16x32_bf16 v[108:111], v[28:31], v[80:83], 0
    v_mfma_f32_16x16x32_bf16 v[112:115], v[48:51], v[80:83], 0
    v_mfma_f32_16x16x32_bf16 v[116:119], v[52:55], v[80:83], 0
    v_mfma_f32_16x16x32_bf16 v[120:123], v[56:59], v[80:83], 0
    v_mfma_f32_16x16x32_bf16 v[124:127], v[60:63], v[80:83], 0
    v_mfma_f32_16x16x32_bf16 v[96:99], v[32:35], v[84:87], v[96:99]
    v_mfma_f32_16x16x32_bf16 v[100:103], v[36:39], v[84:87], v[100:103]
    v_mfma_f32_16x16x32_bf16 v[104:107], v[40:43], v[84:87], v[104:107]
    v_mfma_f32_16x16x32_bf16 v[108:111], v[44:47], v[84:87], v[108:111]
    v_mfma_f32_16x16x32_bf16 v[112:115], v[64:67], v[84:87], v[112:115]
    v_mfma_f32_16x16x32_bf16 v[116:119], v[68:71], v[84:87], v[116:119]
    v_mfma_f32_16x16x32_bf16 v[120:123], v[72:75], v[84:87], v[120:123]
    v_mfma_f32_16x16x32_bf16 v[124:127], v[76:79], v[84:87], v[124:127]
    s_nop 1
    v_cndmask_b32 v16, v96, v100, s[94:95]
    v_cndmask_b32 v17, v97, v101, s[94:95]
    v_cndmask_b32 v18, v98, v102, s[94:95]
    v_cndmask_b32 v19, v99, v103, s[94:95]
    v_cndmask_b32 v16, v16, v104, s[96:97]
    v_cndmask_b32 v17, v17, v105, s[96:97]
    v_cndmask_b32 v18, v18, v106, s[96:97]
    v_cndmask_b32 v19, v19, v107, s[96:97]
    v_cndmask_b32 v16, v16, v108, s[98:99]
    v_cndmask_b32 v17, v17, v109, s[98:99]
    v_cndmask_b32 v18, v18, v110, s[98:99]
    v_cndmask_b32 v19, v19, v111, s[98:99]
    v_cndmask_b32 v20, v112, v116, s[94:95]
    v_cndmask_b32 v21, v113, v117, s[94:95]
    v_cndmask_b32 v22, v114, v118, s[94:95]
    v_cndmask_b32 v23, v115, v119, s[94:95]
    v_cndmask_b32 v20, v20, v120, s[96:97]
    v_cndmask_b32 v21, v21, v121, s[96:97]
    v_cndmask_b32 v22, v22, v122, s[96:97]
    v_cndmask_b32 v23, v23, v123, s[96:97]
    v_cndmask_b32 v20, v20, v124, s[98:99]
    v_cndmask_b32 v21, v21, v125, s[98:99]
    v_cndmask_b32 v22, v22, v126, s[98:99]
    v_cndmask_b32 v23, v23, v127, s[98:99]
    v_add_u32 v16, 0x800, v16
    v_add_u32 v17, 0x800, v17
    v_add_u32 v18, 0x800, v18
    v_add_u32 v19, 0x800, v19
    v_add_u32 v20, 0x800, v20
    v_add_u32 v21, 0x800, v21
    v_add_u32 v22, 0x800, v22
    v_add_u32 v23, 0x800, v23
    v_bfi_b32 v16, s66, v4, v16
    v_bfi_b32 v17, s66, v4, v17
    v_bfi_b32 v18, s66, v4, v18
    v_bfi_b32 v19, s66, v4, v19
    v_bfi_b32 v20, s66, v4, v20
    v_bfi_b32 v21, s66, v4, v21
    v_bfi_b32 v22, s66, v4, v22
    v_bfi_b32 v23, s66, v4, v23
    buffer_store_dwordx4 v[16:19], v1, s[32:35], s50 offen offset:0 sc1
    buffer_store_dwordx4 v[20:23], v1, s[32:35], s50 offen offset:1024 sc1
    s_mov_b64 exec, 1
    ds_add_u32 v5, v6 offset:20
    s_mov_b64 exec, -1
    s_branch L_wo
L_h0b:
    s_waitcnt vmcnt(0)
    ds_read_b64_tr_b16 v[16:17], v12 offset:2048
    ds_read_b64_tr_b16 v[18:19], v12 offset:2560
    ds_read_b64_tr_b16 v[20:21], v12 offset:2080
    ds_read_b64_tr_b16 v[22:23], v12 offset:2592
    ds_read_b64_tr_b16 v[24:25], v12 offset:2304
    ds_read_b64_tr_b16 v[26:27], v12 offset:2816
    ds_read_b64_tr_b16 v[28:29], v12 offset:2336
    ds_read_b64_tr_b16 v[30:31], v12 offset:2848
    ds_read_b64_tr_b16 v[32:33], v12 offset:6272
    ds_read_b64_tr_b16 v[34:35], v12 offset:6784
    ds_read_b64_tr_b16 v[36:37], v12 offset:6304
    ds_read_b64_tr_b16 v[38:39], v12 offset:6816
    ds_read_b64_tr_b16 v[40:41], v12 offset:6528
    ds_read_b64_tr_b16 v[42:43], v12 offset:7040
    ds_read_b64_tr_b16 v[44:45], v12 offset:6560
    ds_read_b64_tr_b16 v[46:47], v12 offset:7072
    ds_read_b64_tr_b16 v[48:49], v12 offset:10496
    ds_read_b64_tr_b16 v[50:51], v12 offset:11008
    ds_read_b64_tr_b16 v[52:53], v12 offset:10528
    ds_read_b64_tr_b16 v[54:55], v12 offset:11040
    ds_read_b64_tr_b16 v[56:57], v12 offset:10752
    ds_read_b64_tr_b16 v[58:59], v12 offset:11264
    ds_read_b64_tr_b16 v[60:61], v12 offset:10784
    ds_read_b64_tr_b16 v[62:63], v12 offset:11296
    ds_read_b64_tr_b16 v[64:65], v12 offset:14720
    ds_read_b64_tr_b16 v[66:67], v12 offset:15232
    ds_read_b64_tr_b16 v[68:69], v12 offset:14752
    ds_read_b64_tr_b16 v[70:71], v12 offset:15264
    ds_read_b64_tr_b16 v[72:73], v12 offset:14976
    ds_read_b64_tr_b16 v[74:75], v12 offset:15488
    ds_read_b64_tr_b16 v[76:77], v12 offset:15008
    ds_read_b64_tr_b16 v[78:79], v12 offset:15520
    s_and_b32 s50, s29, 3
    s_lshl_b32 s51, s50, 8
    v_add_u32 v14, s51, v14
    v_lshlrev_b32 v1, 16, v8
    v_lshl_add_u32 v1, v10, 6, v1
    v_lshl_add_u32 v1, v9, 4, v1
    s_lshl_b32 s50, s50, 11
    s_lshl_b32 s51, s68, 13
    s_add_u32 s50, s50, s51
    s_lshr_b32 s51, s29, 2
    s_lshl_b32 s51, s51, 8
    s_add_u32 s50, s50, s51
    s_add_u32 s50, s50, 262144
    s_mov_b32 s64, 262144
L_spin_3:
    ds_read_b32 v7, v5 offset:0
    s_waitcnt lgkmcnt(0)
    v_cmp_le_u32 vcc, 4, v7
    s_cbranch_vccnz L_spun_4
    s_sub_u32 s64, s64, 1
    s_cmp_lg_u32 s64, 0
    s_cbranch_scc1 L_spin_3
L_spun_4:
    ds_read_b128 v[80:83], v14 offset:60800
    ds_read_b128 v[84:87], v14 offset:60864
    ds_read_b128 v[88:91], v14 offset:60928
    ds_read_b128 v[92:95], v14 offset:60992
    s_waitcnt lgkmcnt(3)
    v_mfma_f32_16x16x32_bf16 v[96:99], v[16:19], v[80:83], 0
    v_mfma_f32_16x16x32_bf16 v[100:103], v[20:23], v[80:83], 0
    v_mfma_f32_16x16x32_bf16 v[104:107], v[24:27], v[80:83], 0
    v_mfma_f32_16x16x32_bf16 v[108:111], v[28:31], v[80:83], 0
    s_waitcnt lgkmcnt(2)
    v_mfma_f32_16x16x32_bf16 v[96:99], v[32:35], v[84:87], v[96:99]
    v_mfma_f32_16x16x32_bf16 v[100:103], v[36:39], v[84:87], v[100:103]
    v_mfma_f32_16x16x32_bf16 v[104:107], v[40:43], v[84:87], v[104:107]
    v_mfma_f32_16x16x32_bf16 v[108:111], v[44:47], v[84:87], v[108:111]
    s_waitcnt lgkmcnt(1)
    v_mfma_f32_16x16x32_bf16 v[96:99], v[48:51], v[88:91], v[96:99]
    v_mfma_f32_16x16x32_bf16 v[100:103], v[52:55], v[88:91], v[100:103]
    v_mfma_f32_16x16x32_bf16 v[104:107], v[56:59], v[88:91], v[104:107]
    v_mfma_f32_16x16x32_bf16 v[108:111], v[60:63], v[88:91], v[108:111]
    s_waitcnt lgkmcnt(0)
    v_mfma_f32_16x16x32_bf16 v[96:99], v[64:67], v[92:95], v[96:99]
    v_mfma_f32_16x16x32_bf16 v[100:103], v[68:71], v[92:95], v[100:103]
    v_mfma_f32_16x16x32_bf16 v[104:107], v[72:75], v[92:95], v[104:107]
    v_mfma_f32_16x16x32_bf16 v[108:111], v[76:79], v[92:95], v[108:111]
    s_nop 5
    v_cndmask_b32 v16, v96, v100, s[94:95]
    v_cndmask_b32 v17, v97, v101, s[94:95]
    v_cndmask_b32 v18, v98, v102, s[94:95]
    v_cndmask_b32 v19, v99, v103, s[94:95]
    v_cndmask_b32 v16, v16, v104, s[96:97]
    v_cndmask_b32 v17, v17, v105, s[96:97]
    v_cndmask_b32 v18, v18, v106, s[96:97]
    v_cndmask_b32 v19, v19, v107, s[96:97]
    v_cndmask_b32 v16, v16, v108, s[98:99]
    v_cndmask_b32 v17, v17, v109, s[98:99]
    v_cndmask_b32 v18, v18, v110, s[98:99]
    v_cndmask_b32 v19, v19, v111, s[98:99]
    s_and_b32 s49, s30, 0xff
    v_mov_b32 v20, s49
    s_movk_i32 s49, 0xff
    v_add_u32 v16, 0x80, v16
    v_add_u32 v17, 0x80, v17
    v_add_u32 v18, 0x80, v18
    v_add_u32 v19, 0x80, v19
    v_bfi_b32 v16, s49, v20, v16
    v_bfi_b32 v17, s49, v20, v17
    v_bfi_b32 v18, s49, v20, v18
    v_bfi_b32 v19, s49, v20, v19
    buffer_store_dwordx4 v[16:19], v1, s[32:35], s50 offen sc1
    s_mov_b64 exec, 1
    ds_add_u32 v5, v6 offset:16
    s_mov_b64 exec, -1
    s_branch L_wo
L_h2b:
    v_lshlrev_b32 v1, 4, v0
    s_lshr_b32 s50, s29, 3
    s_lshl_b32 s50, s50, 16
    s_lshl_b32 s51, s28, 13
    s_add_u32 s50, s50, s51
    s_add_u32 s50, s50, 262144
    s_add_u32 s51, s50, 4096
    s_mov_b32 s64, 262144
L_spin_5:
    ds_read_b32 v7, v5 offset:16
    s_waitcnt lgkmcnt(0)
    v_cmp_le_u32 vcc, 1, v7
    s_cbranch_vccnz L_spun_6
    s_sleep 1
    s_sub_u32 s64, s64, 1
    s_cmp_lg_u32 s64, 0
    s_cbranch_scc1 L_spin_5
L_spun_6:
    s_sleep 16
    s_and_b32 s49, s30, 0xff
    s_mov_b32 s64, 16384
L_poll_7:
    buffer_load_dwordx4 v[16:19], v1, s[32:35], s50 offen offset:0 sc1
    buffer_load_dwordx4 v[20:23], v1, s[32:35], s50 offen offset:1024 sc1
    buffer_load_dwordx4 v[24:27], v1, s[32:35], s50 offen offset:2048 sc1
    buffer_load_dwordx4 v[28:31], v1, s[32:35], s50 offen offset:3072 sc1
    buffer_load_dwordx4 v[32:35], v1, s[32:35], s51 offen offset:0 sc1
    buffer_load_dwordx4 v[36:39], v1, s[32:35], s51 offen offset:1024 sc1
    buffer_load_dwordx4 v[40:43], v1, s[32:35], s51 offen offset:2048 sc1
    buffer_load_dwordx4 v[44:47], v1, s[32:35], s51 offen offset:3072 sc1
    s_waitcnt vmcnt(0)
    v_xor_b32 v16, s49, v16
    v_xor_b32 v17, s49, v17
    v_xor_b32 v18, s49, v18
    v_xor_b32 v19, s49, v19
    v_xor_b32 v20, s49, v20
    v_xor_b32 v21, s49, v21
    v_xor_b32 v22, s49, v22
    v_xor_b32 v23, s49, v23
    v_xor_b32 v24, s49, v24
    v_xor_b32 v25, s49, v25
    v_xor_b32 v26, s49, v26
    v_xor_b32 v27, s49, v27
    v_xor_b32 v28, s49, v28
    v_xor_b32 v29, s49, v29
    v_xor_b32 v30, s49, v30
    v_xor_b32 v31, s49, v31
    v_xor_b32 v32, s49, v32
    v_xor_b32 v33, s49, v33
    v_xor_b32 v34, s49, v34
    v_xor_b32 v35, s49, v35
    v_xor_b32 v36, s49, v36
    v_xor_b32 v37, s49, v37
    v_xor_b32 v38, s49, v38
    v_xor_b32 v39, s49, v39
    v_xor_b32 v40, s49, v40
    v_xor_b32 v41, s49, v41
    v_xor_b32 v42, s49, v42
    v_xor_b32 v43, s49, v43
    v_xor_b32 v44, s49, v44
    v_xor_b32 v45, s49, v45
    v_xor_b32 v46, s49, v46
    v_xor_b32 v47, s49, v47
    v_or3_b32 v7, v16, v17, v18
    v_or3_b32 v7, v7, v19, v20
    v_or3_b32 v7, v7, v21, v22
    v_or3_b32 v7, v7, v23, v24
    v_or3_b32 v7, v7, v25, v26
    v_or3_b32 v7, v7, v27, v28
    v_or3_b32 v7, v7, v29, v30
    v_or3_b32 v7, v7, v31, v32
    v_or3_b32 v7, v7, v33, v34
    v_or3_b32 v7, v7, v35, v36
    v_or3_b32 v7, v7, v37, v38
    v_or3_b32 v7, v7, v39, v40
    v_or3_b32 v7, v7, v41, v42
    v_or3_b32 v7, v7, v43, v44
    v_or3_b32 v7, v7, v45, v46
    v_or_b32 v7, v7, v47
    v_and_b32 v7, 0xff, v7
    v_cmp_ne_u32 vcc, 0, v7
    s_and_b64 exec, vcc, vcc
    s_cbranch_scc0 L_polled_8
    s_sub_u32 s64, s64, 1
    s_cmp_lg_u32 s64, 0
    s_cbranch_scc1 L_poll_7
L_polled_8:
    s_mov_b64 exec, -1
    v_add_f32 v16, v16, v24
    v_add_f32 v32, v32, v40
    v_add_f32 v17, v17, v25
    v_add_f32 v33, v33, v41
    v_add_f32 v18, v18, v26
    v_add_f32 v34, v34, v42
    v_add_f32 v19, v19, v27
    v_add_f32 v35, v35, v43
    v_add_f32 v20, v20, v28
    v_add_f32 v36, v36, v44
    v_add_f32 v21, v21, v29
    v_add_f32 v37, v37, v45
    v_add_f32 v22, v22, v30
    v_add_f32 v38, v38, v46
    v_add_f32 v23, v23, v31
    v_add_f32 v39, v39, v47
    v_add_f32 v16, v16, v32
    v_add_f32 v17, v17, v33
    v_add_f32 v18, v18, v34
    v_add_f32 v19, v19, v35
    v_add_f32 v20, v20, v36
    v_add_f32 v21, v21, v37
    v_add_f32 v22, v22, v38
    v_add_f32 v23, v23, v39
    v_cvt_pk_bf16_f32 v24, v16, v17
    v_cvt_pk_bf16_f32 v25, v18, v19
    v_cvt_pk_bf16_f32 v26, v20, v21
    v_cvt_pk_bf16_f32 v27, v22, v23
    v_lshlrev_b32 v1, 3, v0
    ds_write_b64 v1, v[24:25] offset:1024
    ds_write_b64 v1, v[26:27] offset:1536
    s_mov_b64 exec, 1
    ds_add_u32 v5, v6 offset:4
    s_mov_b64 exec, -1
    s_branch L_wo
L_h3b:
    s_cmp_ge_u32 s29, 28
    s_cbranch_scc1 L_wo
    v_lshlrev_b32 v1, 4, v0
    s_lshr_b32 s50, s48, 2
    s_lshl_b32 s50, s50, 13
    s_add_u32 s50, s50, 524288
    s_add_u32 s51, s50, 4096
    s_mov_b32 s64, 262144
L_spin_9:
    ds_read_b32 v7, v5 offset:20
    s_waitcnt lgkmcnt(0)
    v_cmp_le_u32 vcc, 1, v7
    s_cbranch_vccnz L_spun_10
    s_sleep 1
    s_sub_u32 s64, s64, 1
    s_cmp_lg_u32 s64, 0
    s_cbranch_scc1 L_spin_9
L_spun_10:
    s_sleep 16
    s_mov_b32 s64, 16384
L_poll_11:
    buffer_load_dwordx4 v[48:51], v1, s[32:35], s50 offen offset:0 sc1
    buffer_load_dwordx4 v[52:55], v1, s[32:35], s50 offen offset:1024 sc1
    buffer_load_dwordx4 v[56:59], v1, s[32:35], s50 offen offset:2048 sc1
    buffer_load_dwordx4 v[60:63], v1, s[32:35], s50 offen offset:3072 sc1
    buffer_load_dwordx4 v[64:67], v1, s[32:35], s51 offen offset:0 sc1
    buffer_load_dwordx4 v[68:71], v1, s[32:35], s51 offen offset:1024 sc1
    buffer_load_dwordx4 v[72:75], v1, s[32:35], s51 offen offset:2048 sc1
    buffer_load_dwordx4 v[76:79], v1, s[32:35], s51 offen offset:3072 sc1
    s_waitcnt vmcnt(0)
    v_xor_b32 v48, s31, v48
    v_xor_b32 v49, s31, v49
    v_xor_b32 v50, s31, v50
    v_xor_b32 v51, s31, v51
    v_xor_b32 v52, s31, v52
    v_xor_b32 v53, s31, v53
    v_xor_b32 v54, s31, v54
    v_xor_b32 v55, s31, v55
    v_xor_b32 v56, s31, v56
    v_xor_b32 v57, s31, v57
    v_xor_b32 v58, s31, v58
    v_xor_b32 v59, s31, v59
    v_xor_b32 v60, s31, v60
    v_xor_b32 v61, s31, v61
    v_xor_b32 v62, s31, v62
    v_xor_b32 v63, s31, v63
    v_xor_b32 v64, s31, v64
    v_xor_b32 v65, s31, v65
    v_xor_b32 v66, s31, v66
    v_xor_b32 v67, s31, v67
    v_xor_b32 v68, s31, v68
    v_xor_b32 v69, s31, v69
    v_xor_b32 v70, s31, v70
    v_xor_b32 v71, s31, v71
    v_xor_b32 v72, s31, v72
    v_xor_b32 v73, s31, v73
    v_xor_b32 v74, s31, v74
    v_xor_b32 v75, s31, v75
    v_xor_b32 v76, s31, v76
    v_xor_b32 v77, s31, v77
    v_xor_b32 v78, s31, v78
    v_xor_b32 v79, s31, v79
    v_or3_b32 v7, v48, v49, v50
    v_or3_b32 v7, v7, v51, v52
    v_or3_b32 v7, v7, v53, v54
    v_or3_b32 v7, v7, v55, v56
    v_or3_b32 v7, v7, v57, v58
    v_or3_b32 v7, v7, v59, v60
    v_or3_b32 v7, v7, v61, v62
    v_or3_b32 v7, v7, v63, v64
    v_or3_b32 v7, v7, v65, v66
    v_or3_b32 v7, v7, v67, v68
    v_or3_b32 v7, v7, v69, v70
    v_or3_b32 v7, v7, v71, v72
    v_or3_b32 v7, v7, v73, v74
    v_or3_b32 v7, v7, v75, v76
    v_or3_b32 v7, v7, v77, v78
    v_or_b32 v7, v7, v79
    v_and_b32 v7, 0xfff, v7
    v_cmp_ne_u32 vcc, 0, v7
    s_and_b64 exec, vcc, vcc
    s_cbranch_scc0 L_polled_12
    s_sub_u32 s64, s64, 1
    s_cmp_lg_u32 s64, 0
    s_cbranch_scc1 L_poll_11
L_polled_12:
    s_mov_b64 exec, -1
    v_add_f32 v48, v48, v56
    v_add_f32 v64, v64, v72
    v_add_f32 v49, v49, v57
    v_add_f32 v65, v65, v73
    v_add_f32 v50, v50, v58
    v_add_f32 v66, v66, v74
    v_add_f32 v51, v51, v59
    v_add_f32 v67, v67, v75
    v_add_f32 v52, v52, v60
    v_add_f32 v68, v68, v76
    v_add_f32 v53, v53, v61
    v_add_f32 v69, v69, v77
    v_add_f32 v54, v54, v62
    v_add_f32 v70, v70, v78
    v_add_f32 v55, v55, v63
    v_add_f32 v71, v71, v79
    v_add_f32 v48, v48, v64
    v_add_f32 v49, v49, v65
    v_add_f32 v50, v50, v66
    v_add_f32 v51, v51, v67
    v_add_f32 v52, v52, v68
    v_add_f32 v53, v53, v69
    v_add_f32 v54, v54, v70
    v_add_f32 v55, v55, v71
    v_add_f32_dpp v48, v48, v48 row_ror:8 row_mask:0xf bank_mask:0xf
    v_add_f32_dpp v49, v49, v49 row_ror:8 row_mask:0xf bank_mask:0xf
    v_add_f32_dpp v50, v50, v50 row_ror:8 row_mask:0xf bank_mask:0xf
    v_add_f32_dpp v51, v51, v51 row_ror:8 row_mask:0xf bank_mask:0xf
    v_add_f32_dpp v52, v52, v52 row_ror:8 row_mask:0xf bank_mask:0xf
    v_add_f32_dpp v53, v53, v53 row_ror:8 row_mask:0xf bank_mask:0xf
    v_add_f32_dpp v54, v54, v54 row_ror:8 row_mask:0xf bank_mask:0xf
    v_add_f32_dpp v55, v55, v55 row_ror:8 row_mask:0xf bank_mask:0xf
    v_cvt_pk_bf16_f32 v7, v48, v49
    v_lshlrev_b32 v48, 16, v7
    v_and_b32 v49, 0xffff0000, v7
    v_cvt_pk_bf16_f32 v7, v50, v51
    v_lshlrev_b32 v50, 16, v7
    v_and_b32 v51, 0xffff0000, v7
    v_cvt_pk_bf16_f32 v7, v52, v53
    v_lshlrev_b32 v52, 16, v7
    v_and_b32 v53, 0xffff0000, v7
    v_cvt_pk_bf16_f32 v7, v54, v55
    v_lshlrev_b32 v54, 16, v7
    v_and_b32 v55, 0xffff0000, v7
    v_mul_f32 v56, 0xbfb8aa3b, v48
    v_exp_f32 v56, v56
    s_nop 0
    v_add_f32 v56, 1.0, v56
    v_rcp_f32 v56, v56
    s_nop 0
    v_mul_f32 v48, v48, v56
    v_mul_f32 v57, 0xbfb8aa3b, v49
    v_exp_f32 v57, v57
    s_nop 0
    v_add_f32 v57, 1.0, v57
    v_rcp_f32 v57, v57
    s_nop 0
    v_mul_f32 v49, v49, v57
    v_mul_f32 v58, 0xbfb8aa3b, v50
    v_exp_f32 v58, v58
    s_nop 0
    v_add_f32 v58, 1.0, v58
    v_rcp_f32 v58, v58
    s_nop 0
    v_mul_f32 v50, v50, v58
    v_mul_f32 v59, 0xbfb8aa3b, v51
    v_exp_f32 v59, v59
    s_nop 0
    v_add_f32 v59, 1.0, v59
    v_rcp_f32 v59, v59
    s_nop 0
    v_mul_f32 v51, v51, v59
    v_cvt_pk_bf16_f32 v7, v48, v49
    v_lshlrev_b32 v48, 16, v7
    v_and_b32 v49, 0xffff0000, v7
    v_cvt_pk_bf16_f32 v7, v50, v51
    v_lshlrev_b32 v50, 16, v7
    v_and_b32 v51, 0xffff0000, v7
    v_mul_f32 v48, v48, v52
    v_mul_f32 v49, v49, v53
    v_mul_f32 v50, v50, v54
    v_mul_f32 v51, v51, v55
    v_cvt_pk_bf16_f32 v56, v48, v49
    v_cvt_pk_bf16_f32 v57, v50, v51
    s_mov_b32 vcc_lo, 0xf0f0f0f0
    s_mov_b32 vcc_hi, 0xf0f0f0f0
    v_mov_b32_dpp v58, v56 row_ror:4 row_mask:0xf bank_mask:0xf
    v_mov_b32_dpp v59, v57 row_ror:4 row_mask:0xf bank_mask:0xf
    v_cndmask_b32 v60, v56, v58, vcc
    v_cndmask_b32 v61, v57, v59, vcc
    v_cndmask_b32 v62, v58, v56, vcc
    v_cndmask_b32 v63, v59, v57, vcc
    ds_write_b128 v1, v[60:63] offset:18944
    s_mov_b64 exec, 1
    ds_add_u32 v5, v6 offset:24
    s_mov_b64 exec, -1
L_wo:
    v_lshlrev_b32 v116, 14, v9
    v_bfe_u32 v7, v0, 3, 1
    v_lshl_add_u32 v116, v7, 10, v116
    v_and_b32 v7, 7, v0
    v_lshl_add_u32 v116, v7, 4, v116
    s_lshl_b32 s50, s65, 17
    s_lshl_b32 s51, s67, 11
    s_add_u32 s50, s50, s51
    s_lshr_b32 s51, s100, 3
    s_lshl_b32 s51, s51, 8
    s_add_u32 s50, s50, s51
    s_bfe_u32 s51, s100, 0x10002
    s_lshl_b32 s51, s51, 7
    s_add_u32 s50, s50, s51
    s_add_u32 s53, s50, 1048576
    s_add_u32 s54, s53, 65536
    s_lshl_b32 s55, s65, 3
    s_add_u32 s55, s55, s67
    s_lshl_b32 s55, s55, 8
    s_lshr_b32 s50, s100, 3
    s_lshl_b32 s50, s50, 6
    s_add_u32 s55, s55, s50
    s_add_u32 s55, s55, 1572864
    v_lshlrev_b32 v117, 4, v9
    v_and_b32 v7, 7, v0
    v_lshlrev_b32 v118, 4, v7
    v_bfe_u32 v7, v0, 3, 1
    v_lshl_add_u32 v118, v7, 3, v118
    v_bfe_u32 v7, v0, 5, 1
    v_lshl_add_u32 v118, v7, 1, v118
    v_bfe_u32 v7, v0, 4, 1
    v_lshl_add_u32 v118, v7, 2, v118
    s_mul_i32 s50, s65, 144
    v_add_u32 v118, s50, v118
    s_movk_i32 s50, 144
    v_mul_lo_u32 v119, v8, s50
    v_lshl_add_u32 v119, v9, 4, v119
    v_lshlrev_b32 v124, 6, v8
    v_lshl_add_u32 v124, v9, 4, v124
    v_bfe_u32 v7, v0, 2, 1
    v_lshl_add_u32 v124, v7, 8, v124
    s_lshl_b32 s14, s67, 5
    s_add_u32 s14, s14, s100
    s_lshl_b32 s14, s14, 11
    s_lshl_b32 s50, s65, 9
    s_add_u32 s14, s14, s50
    s_add_u32 s14, s14, 2097152
    s_lshl_b32 s50, s65, 8
    v_add_u32 v13, s50, v13
    s_mov_b32 s56, 2097152
    s_mov_b32 s57, 2162688
    s_mov_b32 s58, 2228224
    s_mov_b32 s59, 2293760
    s_mov_b32 s60, 2359296
    s_mov_b32 s61, 2424832
    s_mov_b32 s62, 2490368
    s_mov_b32 s63, 2555904
    v_lshrrev_b32 v7, 3, v0
    v_lshlrev_b32 v120, 13, v7
    v_and_b32 v7, 7, v0
    v_lshl_add_u32 v120, v7, 4, v120
    s_lshr_b32 s50, s101, 1
    s_lshl_b32 s50, s50, 8
    s_and_b32 s51, s101, 1
    s_lshl_b32 s51, s51, 7
    s_add_u32 s50, s50, s51
    v_add_u32 v120, s50, v120
    v_bfe_u32 v7, v0, 2, 1
    s_and_b32 s50, s101, 1
    s_lshl_b32 s50, s50, 1
    v_add_u32 v7, s50, v7
    v_lshlrev_b32 v123, 10, v7
    v_and_b32 v7, 3, v0
    v_lshl_add_u32 v123, v7, 3, v123
    v_bfe_u32 v7, v0, 5, 1
    v_lshl_add_u32 v123, v7, 1, v123
    v_bfe_u32 v7, v0, 4, 1
    v_lshl_add_u32 v123, v7, 2, v123
    s_lshr_b32 s50, s101, 1
    s_lshl_b32 s50, s50, 5
    v_add_u32 v123, s50, v123

    s_cmp_ge_u32 s2, 64
    s_cbranch_scc1 L_nox
    buffer_load_ushort v122, v123, s[44:47], 0 offen
L_nox:
    s_mov_b32 s40, s12
    s_mov_b32 s41, s13
    s_mov_b32 s42, 4194304
    s_mov_b32 s43, 0x00020000
    s_lshl_b32 s50, s67, 19
    s_lshr_b32 s51, s100, 2
    s_lshl_b32 s51, s51, 16
    s_add_u32 s50, s50, s51
    s_and_b32 s51, s100, 3
    s_lshl_b32 s51, s51, 8
    s_add_u32 s50, s50, s51
    s_lshl_b32 s51, s65, 14
    s_add_u32 s50, s50, s51
    s_mul_i32 s52, s65, 4160
    s_mov_b32 s64, 262144
L_spin_13:
    ds_read_b32 v7, v5 offset:52
    s_waitcnt lgkmcnt(0)
    v_cmp_le_u32 vcc, 8, v7
    s_cbranch_vccnz L_spun_14
    s_sleep 2
    s_sub_u32 s64, s64, 1
    s_cmp_lg_u32 s64, 0
    s_cbranch_scc1 L_spin_13
L_spun_14:
    s_add_u32 m0, s52, 44160
    s_nop 0
    buffer_load_dwordx4 v3, s[40:43], s50 offen nt lds
    s_add_u32 m0, s52, 45200
    s_add_u32 s50, s50, 4096
    buffer_load_dwordx4 v3, s[40:43], s50 offen nt lds
    s_add_u32 m0, s52, 46240
    s_add_u32 s50, s50, 4096
    buffer_load_dwordx4 v3, s[40:43], s50 offen nt lds
    s_add_u32 m0, s52, 47280
    s_add_u32 s50, s50, 4096
    buffer_load_dwordx4 v3, s[40:43], s50 offen nt lds
    s_mov_b32 s64, 262144
L_spin_15:
    ds_read_b32 v7, v5 offset:12
    s_waitcnt lgkmcnt(0)
    v_cmp_le_u32 vcc, 8, v7
    s_cbranch_vccnz L_spun_16
    s_sleep 1
    s_sub_u32 s64, s64, 1
    s_cmp_lg_u32 s64, 0
    s_cbranch_scc1 L_spin_15
L_spun_16:
    s_sleep 12
    buffer_load_dwordx4 v[16:19], v116, s[32:35], s53 offen sc1
    buffer_load_dwordx4 v[20:23], v116, s[32:35], s54 offen sc1
    buffer_load_dwordx4 v[24:27], v117, s[32:35], s55 offen sc1
    s_waitcnt vmcnt(3)
    s_mov_b64 exec, 1
    ds_add_u32 v5, v6 offset:28
    s_mov_b64 exec, -1
    s_mov_b32 s64, 262144
L_spin_20:
    ds_read_b32 v7, v5 offset:28
    s_waitcnt lgkmcnt(0)
    v_cmp_le_u32 vcc, 4, v7
    s_cbranch_vccnz L_spun_21
    s_sleep 1
    s_sub_u32 s64, s64, 1
    s_cmp_lg_u32 s64, 0
    s_cbranch_scc1 L_spin_20
L_spun_21:
    ds_read_b64_tr_b16 v[100:101], v13 offset:44160
    ds_read_b64_tr_b16 v[102:103], v13 offset:45200
    ds_read_b64_tr_b16 v[104:105], v13 offset:52480
    ds_read_b64_tr_b16 v[106:107], v13 offset:53520
    ds_read_b64_tr_b16 v[108:109], v13 offset:44192
    ds_read_b64_tr_b16 v[110:111], v13 offset:45232
    ds_read_b64_tr_b16 v[112:113], v13 offset:52512
    ds_read_b64_tr_b16 v[114:115], v13 offset:53552
    s_mov_b32 s64, 16384
    s_branch L_chk_19
L_poll_17:
    buffer_load_dwordx4 v[16:19], v116, s[32:35], s53 offen sc1
    buffer_load_dwordx4 v[20:23], v116, s[32:35], s54 offen sc1
    buffer_load_dwordx4 v[24:27], v117, s[32:35], s55 offen sc1
L_chk_19:
    s_waitcnt vmcnt(0)
    v_xor_b32 v16, s31, v16
    v_xor_b32 v17, s31, v17
    v_xor_b32 v18, s31, v18
    v_xor_b32 v19, s31, v19
    v_xor_b32 v20, s31, v20
    v_xor_b32 v21, s31, v21
    v_xor_b32 v22, s31, v22
    v_xor_b32 v23, s31, v23
    v_xor_b32 v24, s31, v24
    v_xor_b32 v25, s31, v25
    v_xor_b32 v26, s31, v26
    v_xor_b32 v27, s31, v27
    v_or3_b32 v7, v16, v17, v18
    v_or3_b32 v7, v7, v19, v20
    v_or3_b32 v7, v7, v21, v22
    v_or3_b32 v7, v7, v23, v24
    v_or3_b32 v7, v7, v25, v26
    v_or_b32 v7, v7, v27
    v_and_b32 v7, 0xfff, v7
    v_cmp_ne_u32 vcc, 0, v7
    s_and_b64 exec, vcc, vcc
    s_cbranch_scc0 L_polled_18
    s_sub_u32 s64, s64, 1
    s_cmp_lg_u32 s64, 0
    s_cbranch_scc1 L_poll_17
L_polled_18:
    s_mov_b64 exec, -1
    v_max_f32 v28, v24, v26
    v_mov_b32 v7, v28
    s_nop 1
    v_permlane32_swap_b32 v28, v7
    v_max_f32 v28, v28, v7
    v_mov_b32 v7, v28
    s_nop 1
    v_permlane16_swap_b32 v28, v7
    v_max_f32 v28, v28, v7
    v_sub_f32 v24, v24, v28
    v_sub_f32 v26, v26, v28
    v_mul_f32 v24, 0x3fb8aa3b, v24
    v_mul_f32 v26, 0x3fb8aa3b, v26
    v_exp_f32 v24, v24
    v_exp_f32 v26, v26
    s_nop 0
    v_mul_f32 v25, v25, v24
    v_fmac_f32 v25, v27, v26
    v_mul_f32 v16, v16, v24
    v_mul_f32 v17, v17, v24
    v_mul_f32 v18, v18, v24
    v_mul_f32 v19, v19, v24
    v_fmac_f32 v16, v20, v26
    v_fmac_f32 v17, v21, v26
    v_fmac_f32 v18, v22, v26
    v_fmac_f32 v19, v23, v26
    v_mov_b32 v7, v25
    s_nop 1
    v_permlane32_swap_b32 v25, v7
    v_add_f32 v25, v25, v7
    v_mov_b32 v7, v25
    s_nop 1
    v_permlane16_swap_b32 v25, v7
    v_add_f32 v25, v25, v7
    v_permlane32_swap_b32 v16, v17
    v_permlane32_swap_b32 v18, v19
    v_add_f32 v16, v16, v17
    v_add_f32 v18, v18, v19
    s_nop 1
    v_permlane16_swap_b32 v16, v18
    v_add_f32 v16, v16, v18
    v_rcp_f32 v25, v25
    s_nop 0
    v_mul_f32 v16, v16, v25
    v_cvt_pk_bf16_f32 v16, v16, v16
    ds_write_b16 v118, v16 offset:320
    s_mov_b64 exec, 1
    ds_add_u32 v5, v6 offset:40
    s_mov_b64 exec, -1
    s_mov_b32 s64, 262144
L_spin_22:
    ds_read_b32 v7, v5 offset:40
    ds_read_b128 v[16:19], v119 offset:320
    ds_read_b128 v[20:23], v119 offset:384
    s_waitcnt lgkmcnt(0)
    v_cmp_le_u32 vcc, 4, v7
    s_cbranch_vccnz L_spun_23
    s_sub_u32 s64, s64, 1
    s_cmp_lg_u32 s64, 0
    s_cbranch_scc1 L_spin_22
L_spun_23:
    v_mfma_f32_16x16x32_bf16 v[24:27], v[100:103], v[16:19], 0
    v_mfma_f32_16x16x32_bf16 v[28:31], v[108:111], v[16:19], 0
    v_mfma_f32_16x16x32_bf16 v[24:27], v[104:107], v[20:23], v[24:27]
    v_mfma_f32_16x16x32_bf16 v[28:31], v[112:115], v[20:23], v[28:31]
    s_nop 7
    v_cndmask_b32 v24, v24, v28, s[94:95]
    v_cndmask_b32 v25, v25, v29, s[94:95]
    v_cndmask_b32 v26, v26, v30, s[94:95]
    v_cndmask_b32 v27, v27, v31, s[94:95]
    v_add_u32 v24, 0x800, v24
    v_add_u32 v25, 0x800, v25
    v_add_u32 v26, 0x800, v26
    v_add_u32 v27, 0x800, v27
    v_bfi_b32 v24, s66, v4, v24
    v_bfi_b32 v25, s66, v4, v25
    v_bfi_b32 v26, s66, v4, v26
    v_bfi_b32 v27, s66, v4, v27
    s_mov_b32 exec_lo, 0x00ff00ff
    s_mov_b32 exec_hi, 0x00ff00ff
    buffer_store_dwordx4 v[24:27], v124, s[32:35], s14 offen sc1
    s_mov_b64 exec, -1
    s_cmp_ge_u32 s2, 64
    s_cbranch_scc1 L_hdone
    s_mov_b32 s36, s22
    s_mov_b32 s37, s23
    s_mov_b32 s38, 4096
    s_mov_b32 s39, 0x00020000
    v_lshlrev_b32 v1, 2, v0
    v_lshlrev_b32 v122, 16, v122
    s_mov_b32 s50, s65
L_stag:
    s_cmp_eq_u32 s50, 0
    s_cbranch_scc1 L_staged
    s_sleep 7
    s_sub_u32 s50, s50, 1
    s_branch L_stag
L_staged:
    s_mov_b32 s64, 16384
L_poll_24:
    buffer_load_dwordx4 v[32:35], v120, s[32:35], s56 offen sc1
    buffer_load_dwordx4 v[36:39], v120, s[32:35], s57 offen sc1
    buffer_load_dwordx4 v[40:43], v120, s[32:35], s58 offen sc1
    buffer_load_dwordx4 v[44:47], v120, s[32:35], s59 offen sc1
    buffer_load_dwordx4 v[48:51], v120, s[32:35], s60 offen sc1
    buffer_load_dwordx4 v[52:55], v120, s[32:35], s61 offen sc1
    buffer_load_dwordx4 v[56:59], v120, s[32:35], s62 offen sc1
    buffer_load_dwordx4 v[60:63], v120, s[32:35], s63 offen sc1
    ds_read_b32 v17, v5 offset:48
    s_waitcnt vmcnt(0)
    v_xor_b32 v32, s31, v32
    v_xor_b32 v33, s31, v33
    v_xor_b32 v34, s31, v34
    v_xor_b32 v35, s31, v35
    v_xor_b32 v36, s31, v36
    v_xor_b32 v37, s31, v37
    v_xor_b32 v38, s31, v38
    v_xor_b32 v39, s31, v39
    v_xor_b32 v40, s31, v40
    v_xor_b32 v41, s31, v41
    v_xor_b32 v42, s31, v42
    v_xor_b32 v43, s31, v43
    v_xor_b32 v44, s31, v44
    v_xor_b32 v45, s31, v45
    v_xor_b32 v46, s31, v46
    v_xor_b32 v47, s31, v47
    v_xor_b32 v48, s31, v48
    v_xor_b32 v49, s31, v49
    v_xor_b32 v50, s31, v50
    v_xor_b32 v51, s31, v51
    v_xor_b32 v52, s31, v52
    v_xor_b32 v53, s31, v53
    v_xor_b32 v54, s31, v54
    v_xor_b32 v55, s31, v55
    v_xor_b32 v56, s31, v56
    v_xor_b32 v57, s31, v57
    v_xor_b32 v58, s31, v58
    v_xor_b32 v59, s31, v59
    v_xor_b32 v60, s31, v60
    v_xor_b32 v61, s31, v61
    v_xor_b32 v62, s31, v62
    v_xor_b32 v63, s31, v63
    v_or3_b32 v7, v32, v33, v34
    v_or3_b32 v7, v7, v35, v36
    v_or3_b32 v7, v7, v37, v38
    v_or3_b32 v7, v7, v39, v40
    v_or3_b32 v7, v7, v41, v42
    v_or3_b32 v7, v7, v43, v44
    v_or3_b32 v7, v7, v45, v46
    v_or3_b32 v7, v7, v47, v48
    v_or3_b32 v7, v7, v49, v50
    v_or3_b32 v7, v7, v51, v52
    v_or3_b32 v7, v7, v53, v54
    v_or3_b32 v7, v7, v55, v56
    v_or3_b32 v7, v7, v57, v58
    v_or3_b32 v7, v7, v59, v60
    v_or3_b32 v7, v7, v61, v62
    v_or_b32 v7, v7, v63
    v_and_b32 v7, 0xfff, v7
    v_cmp_ne_u32 vcc, 0, v7
    s_and_b64 exec, vcc, vcc
    s_cbranch_scc0 L_polled_25
    s_waitcnt lgkmcnt(0)
    v_readfirstlane_b32 s50, v17
    s_cmp_lg_u32 s50, 0
    s_cbranch_scc1 L_hbail
    s_sub_u32 s64, s64, 1
    s_cmp_lg_u32 s64, 0
    s_cbranch_scc1 L_poll_24
L_polled_25:
    s_mov_b64 exec, -1
    s_mov_b64 exec, 1
    ds_add_rtn_u32 v17, v5, v6 offset:48
    s_mov_b64 exec, -1
    ds_read_b32 v16, v5 offset:36
    ds_read_b32 v121, v1 offset:65152
    v_add_f32 v32, v32, v48
    v_add_f32 v33, v33, v49
    v_add_f32 v34, v34, v50
    v_add_f32 v35, v35, v51
    v_add_f32 v36, v36, v52
    v_add_f32 v37, v37, v53
    v_add_f32 v38, v38, v54
    v_add_f32 v39, v39, v55
    v_add_f32 v40, v40, v56
    v_add_f32 v41, v41, v57
    v_add_f32 v42, v42, v58
    v_add_f32 v43, v43, v59
    v_add_f32 v44, v44, v60
    v_add_f32 v45, v45, v61
    v_add_f32 v46, v46, v62
    v_add_f32 v47, v47, v63
    v_add_f32 v32, v32, v40
    v_add_f32 v33, v33, v41
    v_add_f32 v34, v34, v42
    v_add_f32 v35, v35, v43
    v_add_f32 v36, v36, v44
    v_add_f32 v37, v37, v45
    v_add_f32 v38, v38, v46
    v_add_f32 v39, v39, v47
    v_add_f32 v32, v32, v36
    v_add_f32 v33, v33, v37
    v_add_f32 v34, v34, v38
    v_add_f32 v35, v35, v39
    v_permlane32_swap_b32 v32, v33
    s_nop 0
    v_permlane32_swap_b32 v34, v35
    v_add_f32 v32, v32, v33
    v_add_f32 v34, v34, v35
    s_nop 1
    v_permlane16_swap_b32 v32, v34
    v_add_f32 v32, v32, v34
    s_nop 1
    v_add_f32_dpp v32, v32, v32 row_ror:8 row_mask:0xf bank_mask:0xf
    v_cvt_pk_bf16_f32 v32, v32, v32
    s_waitcnt lgkmcnt(0)
    v_readfirstlane_b32 s50, v17
    s_cmp_lg_u32 s50, 0
    s_cbranch_scc1 L_hbail
    v_cmp_le_u32 vcc, 1, v16
    v_and_b32 v32, 0xffff0000, v32
    s_cbranch_vccnz L_gok
    s_mov_b32 s64, 262144
L_spin_26:
    ds_read_b32 v7, v5 offset:36
    ds_read_b32 v121, v1 offset:65152
    s_waitcnt lgkmcnt(0)
    v_cmp_le_u32 vcc, 1, v7
    s_cbranch_vccnz L_spun_27
    s_sleep 1
    s_sub_u32 s64, s64, 1
    s_cmp_lg_u32 s64, 0
    s_cbranch_scc1 L_spin_26
L_spun_27:
L_gok:
    v_mul_f32 v32, v32, v121
    v_cvt_pk_bf16_f32 v32, v32, v32
    v_and_b32 v32, 0xffff0000, v32
    v_add_f32 v32, v32, v122
    v_cvt_pk_bf16_f32 v32, v32, v32
    s_mov_b32 exec_lo, 0x00ff00ff
    s_mov_b32 exec_hi, 0x00ff00ff
    buffer_store_short v32, v123, s[36:39], 0 offen
    s_mov_b64 exec, -1
    s_cmp_lg_u32 s2, 0
    s_cbranch_scc1 L_hdone
    v_mov_b32 v33, s30
    s_mov_b64 exec, 1
    buffer_store_dword v33, v5, s[32:35], 0 offen sc1
    s_mov_b64 exec, -1
L_hbail:
    s_mov_b64 exec, -1
L_hdone:
L_end:
    s_endpgm
L_swave:
    v_and_b32 v7, 15, v0
    v_lshrrev_b32 v7, 2, v7
    v_lshlrev_b32 v1, 8, v7
    v_lshrrev_b32 v7, 4, v0
    v_lshl_add_u32 v1, v7, 6, v1
    v_and_b32 v7, 3, v0
    v_lshl_add_u32 v1, v7, 4, v1
    v_lshlrev_b32 v2, 4, v0
    v_mov_b32 v5, 0
    v_mov_b32 v6, 1
    s_lshr_b32 s50, s29, 3
    s_lshl_b32 s50, s50, 3
    s_add_u32 s50, s50, s28
    s_lshl_b32 s50, s50, 20

    s_bfe_u32 s51, s29, 0x30000
    s_lshl_b32 s51, s51, 17
    s_add_u32 s50, s50, s51
    s_bfe_u32 s51, s3, 0x30000
    s_lshl_b32 s51, s51, 14
    s_add_u32 s50, s50, s51
    s_mov_b32 s52, 4096
    s_mov_b32 s53, 8192
    s_mov_b32 s54, 12288
    s_waitcnt lgkmcnt(0)
    s_barrier
    s_add_u32 s36, s6, s50
    s_addc_u32 s37, s7, 0
    s_mov_b32 s38, 16384
    s_mov_b32 s39, 0x00020000
    s_add_u32 s40, s8, s50
    s_addc_u32 s41, s9, 0
    s_mov_b32 s42, 16384
    s_mov_b32 s43, 0x00020000
    s_setprio 1
    buffer_load_dwordx4 v[8:11], v1, s[36:39], 0 offen offset:0 nt
    s_mov_b32 s32, s26
    s_mov_b32 s33, s27
    s_mov_b32 s34, 8388608
    s_mov_b32 s35, 0x00020000
    s_load_dword s30, s[26:27], 0
    buffer_load_dwordx4 v[12:15], v1, s[36:39], 0 offen offset:1024 nt
    buffer_load_dwordx4 v[16:19], v1, s[36:39], 0 offen offset:2048 nt
    buffer_load_dwordx4 v[20:23], v1, s[36:39], 0 offen offset:3072 nt
    buffer_load_dwordx4 v[24:27], v1, s[36:39], s52 offen offset:0 nt
    buffer_load_dwordx4 v[28:31], v1, s[36:39], s52 offen offset:1024 nt
    buffer_load_dwordx4 v[32:35], v1, s[36:39], s52 offen offset:2048 nt
    buffer_load_dwordx4 v[36:39], v1, s[36:39], s52 offen offset:3072 nt
    buffer_load_dwordx4 v[40:43], v1, s[36:39], s53 offen offset:0 nt
    buffer_load_dwordx4 v[44:47], v1, s[36:39], s53 offen offset:1024 nt
    buffer_load_dwordx4 v[48:51], v1, s[36:39], s53 offen offset:2048 nt
    buffer_load_dwordx4 v[52:55], v1, s[36:39], s53 offen offset:3072 nt
    buffer_load_dwordx4 v[56:59], v1, s[36:39], s54 offen offset:0 nt
    buffer_load_dwordx4 v[60:63], v1, s[36:39], s54 offen offset:1024 nt
    buffer_load_dwordx4 v[64:67], v1, s[36:39], s54 offen offset:2048 nt
    buffer_load_dwordx4 v[68:71], v1, s[36:39], s54 offen offset:3072 nt
    s_setprio 0
    s_and_b32 s50, s28, 3
    s_lshr_b32 s51, s28, 2
    s_lshl_b32 s67, s50, 1
    s_lshr_b32 s52, s29, 4
    s_add_u32 s67, s67, s52
    s_lshl_b32 s52, s51, 2
    s_add_u32 s67, s67, s52
    s_add_u32 s67, s67, 2
    s_and_b32 s67, s67, 7
    s_and_b32 s52, s29, 1
    s_lshl1_add_u32 s52, s51, s52
    s_bfe_u32 s100, s29, 0x30001
    s_lshl2_add_u32 s100, s100, s52
    s_mul_i32 s48, s50, 28
    s_add_u32 s48, s48, s29
    s_lshr_b32 s48, s48, 1
    s_lshl2_add_u32 s48, s48, s52
    s_lshl_b32 s101, s50, 3
    s_add_u32 s101, s101, s29
    s_xor_b32 s52, s52, 2
    s_lshl_b32 s52, s52, 4
    s_bfe_u32 s69, s101, 0x30001
    s_lshl1_add_u32 s52, s69, s52
    s_lshr_b32 s101, s101, 4
    s_add_u32 s101, s101, s52
    s_mul_i32 s52, s29, 37
    s_lshr_b32 s52, s52, 8
    s_mul_i32 s69, s52, 7
    s_sub_u32 s69, s29, s69
    s_add_u32 s50, s50, 1
    s_and_b32 s50, s50, 3
    s_mul_i32 s50, s50, 7
    s_add_u32 s69, s69, s50
    s_lshl_b32 s69, s69, 3
    s_lshl2_add_u32 s52, s51, s52
    s_add_u32 s69, s69, s52
    s_add_u32 s68, s28, 4
    s_and_b32 s68, s68, 7
    s_mov_b32 s52, 4096
    v_and_b32 v7, 3, v0
    v_mov_b32 v144, 0xffff
    s_mov_b32 s56, 0x22222222
    s_mov_b32 s57, 0x22222222
    s_mov_b32 s58, 0x44444444
    s_mov_b32 s59, 0x44444444
    s_mov_b32 s60, 0x88888888
    s_mov_b32 s61, 0x88888888
    v_cmp_eq_u32 vcc, 0, v7
    v_mov_b32 v4, 0xffff0000
    s_nop 0
    v_cndmask_b32 v3, 0, v144, vcc
    v_cndmask_b32 v3, v3, v4, s[56:57]
    v_cndmask_b32 v7, 0, v144, s[58:59]
    v_cndmask_b32 v4, v7, v4, s[60:61]
    v_lshrrev_b32 v7, 2, v0
    v_and_b32 v7, 3, v7
    v_lshlrev_b32 v147, 8, v7
    v_lshlrev_b32 v144, 5, v7
    v_lshrrev_b32 v7, 4, v0
    v_lshl_add_u32 v147, v7, 6, v147
    v_lshlrev_b32 v149, 5, v7
    s_lshl_b32 s50, s3, 2
    v_add_u32 v148, s50, v149
    v_add_u32 v144, s50, v144
    v_add_u32 v150, 65536, v2
    s_lshl_b32 s50, s3, 11
    v_add_u32 v151, s50, v150
    v_and_b32 v7, 3, v0
    v_lshl_add_u32 v147, v7, 4, v147
    s_waitcnt lgkmcnt(0)
    s_add_u32 s30, s30, 1
    s_and_b32 s31, s30, 0xfff
    s_mov_b32 s15, 0
    s_mov_b32 s64, 262144
L_turn:
    ds_read_b32 v7, v5 offset:4
    ds_read_b32 v1, v5 offset:32
    s_waitcnt lgkmcnt(0)
    v_readfirstlane_b32 s50, v7
    v_readfirstlane_b32 s51, v1
    s_cmp_lg_u32 s50, 0
    s_cbranch_scc1 L_qkfirst
    s_add_u32 s51, s51, 3
    s_cmp_gt_u32 s51, s3
    s_cbranch_scc1 L_vfirst
    s_sleep 2
    s_sub_u32 s64, s64, 1
    s_cmp_lg_u32 s64, 0
    s_cbranch_scc1 L_turn
L_vfirst:
    buffer_load_dwordx4 v[72:75], v2, s[40:43], 0 offen offset:0 nt
    buffer_load_dwordx4 v[76:79], v2, s[40:43], 0 offen offset:1024 nt
    buffer_load_dwordx4 v[80:83], v2, s[40:43], 0 offen offset:2048 nt
    buffer_load_dwordx4 v[84:87], v2, s[40:43], 0 offen offset:3072 nt
    buffer_load_dwordx4 v[88:91], v2, s[40:43], s52 offen offset:0 nt
    buffer_load_dwordx4 v[92:95], v2, s[40:43], s52 offen offset:1024 nt
    buffer_load_dwordx4 v[96:99], v2, s[40:43], s52 offen offset:2048 nt
    buffer_load_dwordx4 v[100:103], v2, s[40:43], s52 offen offset:3072 nt
    buffer_load_dwordx4 v[104:107], v2, s[40:43], s53 offen offset:0 nt
    buffer_load_dwordx4 v[108:111], v2, s[40:43], s53 offen offset:1024 nt
    buffer_load_dwordx4 v[112:115], v2, s[40:43], s53 offen offset:2048 nt
    buffer_load_dwordx4 v[116:119], v2, s[40:43], s53 offen offset:3072 nt
    buffer_load_dwordx4 v[120:123], v2, s[40:43], s54 offen offset:0 nt
    buffer_load_dwordx4 v[124:127], v2, s[40:43], s54 offen offset:1024 nt
    buffer_load_dwordx4 v[128:131], v2, s[40:43], s54 offen offset:2048 nt
    buffer_load_dwordx4 v[132:135], v2, s[40:43], s54 offen offset:3072 nt
    s_mov_b64 exec, 1
    ds_add_u32 v5, v6 offset:32
    s_mov_b64 exec, -1
    s_waitcnt vmcnt(16)
    s_branch L_qk
L_qkfirst:
    s_mov_b32 s15, 1
    s_waitcnt vmcnt(0)
L_qk:
    s_mov_b32 s64, 262144
L_spin_28:
    ds_read_b32 v7, v5 offset:4
    ds_read_b128 v[136:139], v147 offset:1024
    s_waitcnt lgkmcnt(0)
    v_cmp_le_u32 vcc, 1, v7
    s_cbranch_vccnz L_spun_29
    s_sleep 1
    s_sub_u32 s64, s64, 1
    s_cmp_lg_u32 s64, 0
    s_cbranch_scc1 L_spin_28
L_spun_29:
    v_mfma_f32_16x16x32_bf16 v[8:11], v[8:11], v[136:139], 0
    v_mfma_f32_16x16x32_bf16 v[12:15], v[12:15], v[136:139], 0
    v_mfma_f32_16x16x32_bf16 v[16:19], v[16:19], v[136:139], 0
    v_mfma_f32_16x16x32_bf16 v[20:23], v[20:23], v[136:139], 0
    v_mfma_f32_16x16x32_bf16 v[24:27], v[24:27], v[136:139], 0
    v_mfma_f32_16x16x32_bf16 v[28:31], v[28:31], v[136:139], 0
    v_mfma_f32_16x16x32_bf16 v[32:35], v[32:35], v[136:139], 0
    v_mfma_f32_16x16x32_bf16 v[36:39], v[36:39], v[136:139], 0
    v_mfma_f32_16x16x32_bf16 v[40:43], v[40:43], v[136:139], 0
    v_mfma_f32_16x16x32_bf16 v[44:47], v[44:47], v[136:139], 0
    v_mfma_f32_16x16x32_bf16 v[48:51], v[48:51], v[136:139], 0
    v_mfma_f32_16x16x32_bf16 v[52:55], v[52:55], v[136:139], 0
    v_mfma_f32_16x16x32_bf16 v[56:59], v[56:59], v[136:139], 0
    v_mfma_f32_16x16x32_bf16 v[60:63], v[60:63], v[136:139], 0
    v_mfma_f32_16x16x32_bf16 v[64:67], v[64:67], v[136:139], 0
    v_mfma_f32_16x16x32_bf16 v[68:71], v[68:71], v[136:139], 0
    v_add_f32_dpp v8, v9, v8 quad_perm:[1,0,3,2] row_mask:0xf bank_mask:0xf
    v_add_f32_dpp v10, v11, v10 quad_perm:[1,0,3,2] row_mask:0xf bank_mask:0xf
    v_add_f32_dpp v13, v12, v13 quad_perm:[1,0,3,2] row_mask:0xf bank_mask:0xf
    v_add_f32_dpp v15, v14, v15 quad_perm:[1,0,3,2] row_mask:0xf bank_mask:0xf
    v_add_f32_dpp v18, v19, v18 quad_perm:[1,0,3,2] row_mask:0xf bank_mask:0xf
    v_add_f32_dpp v16, v17, v16 quad_perm:[1,0,3,2] row_mask:0xf bank_mask:0xf
    v_add_f32_dpp v23, v22, v23 quad_perm:[1,0,3,2] row_mask:0xf bank_mask:0xf
    v_add_f32_dpp v21, v20, v21 quad_perm:[1,0,3,2] row_mask:0xf bank_mask:0xf
    v_add_f32_dpp v8, v10, v8 quad_perm:[2,3,0,1] row_mask:0xf bank_mask:0xf
    v_add_f32_dpp v13, v15, v13 quad_perm:[2,3,0,1] row_mask:0xf bank_mask:0xf
    v_add_f32_dpp v18, v16, v18 quad_perm:[2,3,0,1] row_mask:0xf bank_mask:0xf
    v_add_f32_dpp v23, v21, v23 quad_perm:[2,3,0,1] row_mask:0xf bank_mask:0xf
    v_cndmask_b32 v140, v8, v13, s[56:57]
    v_cndmask_b32 v140, v140, v18, s[58:59]
    v_cndmask_b32 v140, v140, v23, s[60:61]
    v_add_f32_dpp v24, v25, v24 quad_perm:[1,0,3,2] row_mask:0xf bank_mask:0xf
    v_add_f32_dpp v26, v27, v26 quad_perm:[1,0,3,2] row_mask:0xf bank_mask:0xf
    v_add_f32_dpp v29, v28, v29 quad_perm:[1,0,3,2] row_mask:0xf bank_mask:0xf
    v_add_f32_dpp v31, v30, v31 quad_perm:[1,0,3,2] row_mask:0xf bank_mask:0xf
    v_add_f32_dpp v34, v35, v34 quad_perm:[1,0,3,2] row_mask:0xf bank_mask:0xf
    v_add_f32_dpp v32, v33, v32 quad_perm:[1,0,3,2] row_mask:0xf bank_mask:0xf
    v_add_f32_dpp v39, v38, v39 quad_perm:[1,0,3,2] row_mask:0xf bank_mask:0xf
    v_add_f32_dpp v37, v36, v37 quad_perm:[1,0,3,2] row_mask:0xf bank_mask:0xf
    v_add_f32_dpp v24, v26, v24 quad_perm:[2,3,0,1] row_mask:0xf bank_mask:0xf
    v_add_f32_dpp v29, v31, v29 quad_perm:[2,3,0,1] row_mask:0xf bank_mask:0xf
    v_add_f32_dpp v34, v32, v34 quad_perm:[2,3,0,1] row_mask:0xf bank_mask:0xf
    v_add_f32_dpp v39, v37, v39 quad_perm:[2,3,0,1] row_mask:0xf bank_mask:0xf
    v_cndmask_b32 v141, v24, v29, s[56:57]
    v_cndmask_b32 v141, v141, v34, s[58:59]
    v_cndmask_b32 v141, v141, v39, s[60:61]
    v_add_f32_dpp v40, v41, v40 quad_perm:[1,0,3,2] row_mask:0xf bank_mask:0xf
    v_add_f32_dpp v42, v43, v42 quad_perm:[1,0,3,2] row_mask:0xf bank_mask:0xf
    v_add_f32_dpp v45, v44, v45 quad_perm:[1,0,3,2] row_mask:0xf bank_mask:0xf
    v_add_f32_dpp v47, v46, v47 quad_perm:[1,0,3,2] row_mask:0xf bank_mask:0xf
    v_add_f32_dpp v50, v51, v50 quad_perm:[1,0,3,2] row_mask:0xf bank_mask:0xf
    v_add_f32_dpp v48, v49, v48 quad_perm:[1,0,3,2] row_mask:0xf bank_mask:0xf
    v_add_f32_dpp v55, v54, v55 quad_perm:[1,0,3,2] row_mask:0xf bank_mask:0xf
    v_add_f32_dpp v53, v52, v53 quad_perm:[1,0,3,2] row_mask:0xf bank_mask:0xf
    v_add_f32_dpp v40, v42, v40 quad_perm:[2,3,0,1] row_mask:0xf bank_mask:0xf
    v_add_f32_dpp v45, v47, v45 quad_perm:[2,3,0,1] row_mask:0xf bank_mask:0xf
    v_add_f32_dpp v50, v48, v50 quad_perm:[2,3,0,1] row_mask:0xf bank_mask:0xf
    v_add_f32_dpp v55, v53, v55 quad_perm:[2,3,0,1] row_mask:0xf bank_mask:0xf
    v_cndmask_b32 v142, v40, v45, s[56:57]
    v_cndmask_b32 v142, v142, v50, s[58:59]
    v_cndmask_b32 v142, v142, v55, s[60:61]
    v_add_f32_dpp v56, v57, v56 quad_perm:[1,0,3,2] row_mask:0xf bank_mask:0xf
    v_add_f32_dpp v58, v59, v58 quad_perm:[1,0,3,2] row_mask:0xf bank_mask:0xf
    v_add_f32_dpp v61, v60, v61 quad_perm:[1,0,3,2] row_mask:0xf bank_mask:0xf
    v_add_f32_dpp v63, v62, v63 quad_perm:[1,0,3,2] row_mask:0xf bank_mask:0xf
    v_add_f32_dpp v66, v67, v66 quad_perm:[1,0,3,2] row_mask:0xf bank_mask:0xf
    v_add_f32_dpp v64, v65, v64 quad_perm:[1,0,3,2] row_mask:0xf bank_mask:0xf
    v_add_f32_dpp v71, v70, v71 quad_perm:[1,0,3,2] row_mask:0xf bank_mask:0xf
    v_add_f32_dpp v69, v68, v69 quad_perm:[1,0,3,2] row_mask:0xf bank_mask:0xf
    v_add_f32_dpp v56, v58, v56 quad_perm:[2,3,0,1] row_mask:0xf bank_mask:0xf
    v_add_f32_dpp v61, v63, v61 quad_perm:[2,3,0,1] row_mask:0xf bank_mask:0xf
    v_add_f32_dpp v66, v64, v66 quad_perm:[2,3,0,1] row_mask:0xf bank_mask:0xf
    v_add_f32_dpp v71, v69, v71 quad_perm:[2,3,0,1] row_mask:0xf bank_mask:0xf
    v_cndmask_b32 v143, v56, v61, s[56:57]
    v_cndmask_b32 v143, v143, v66, s[58:59]
    v_cndmask_b32 v143, v143, v71, s[60:61]
    v_cvt_pk_bf16_f32 v7, v140, v141
    v_lshlrev_b32 v140, 16, v7
    v_and_b32 v141, 0xffff0000, v7
    v_cvt_pk_bf16_f32 v145, v142, v143
    v_lshlrev_b32 v142, 16, v145
    v_and_b32 v143, 0xffff0000, v145
    v_mul_f32 v140, 0x3db504f3, v140
    v_mul_f32 v141, 0x3db504f3, v141
    v_mul_f32 v142, 0x3db504f3, v142
    v_mul_f32 v143, 0x3db504f3, v143
    v_cvt_pk_bf16_f32 v7, v140, v141
    v_lshlrev_b32 v140, 16, v7
    v_and_b32 v141, 0xffff0000, v7
    v_cvt_pk_bf16_f32 v145, v142, v143
    v_lshlrev_b32 v142, 16, v145
    v_and_b32 v143, 0xffff0000, v145
    v_max3_f32 v145, v140, v141, v142
    v_max_f32 v145, v145, v143
    s_nop 1
    v_max_f32_dpp v145, v145, v145 quad_perm:[1,0,3,2] row_mask:0xf bank_mask:0xf
    s_nop 1
    v_max_f32_dpp v145, v145, v145 quad_perm:[2,3,0,1] row_mask:0xf bank_mask:0xf
    v_mov_b32 v7, v145
    s_nop 1
    v_permlane32_swap_b32 v145, v7
    v_max_f32 v145, v145, v7
    v_mov_b32 v7, v145
    s_nop 1
    v_permlane16_swap_b32 v145, v7
    v_max_f32 v145, v145, v7
    ds_write_b32 v144, v145 offset:64
    v_sub_f32 v140, v140, v145
    v_sub_f32 v141, v141, v145
    v_sub_f32 v142, v142, v145
    v_sub_f32 v143, v143, v145
    v_mul_f32 v140, 0x3fb8aa3b, v140
    v_mul_f32 v141, 0x3fb8aa3b, v141
    v_mul_f32 v142, 0x3fb8aa3b, v142
    v_mul_f32 v143, 0x3fb8aa3b, v143
    v_exp_f32 v140, v140
    v_exp_f32 v141, v141
    v_exp_f32 v142, v142
    v_exp_f32 v143, v143
    v_add_f32 v146, v140, v141
    v_add_f32 v7, v142, v143
    v_add_f32 v146, v146, v7
    v_cvt_pk_bf16_f32 v140, v140, v140
    v_cvt_pk_bf16_f32 v141, v141, v141
    v_cvt_pk_bf16_f32 v142, v142, v142
    v_cvt_pk_bf16_f32 v143, v143, v143
    v_add_f32_dpp v146, v146, v146 quad_perm:[1,0,3,2] row_mask:0xf bank_mask:0xf
    s_nop 1
    v_add_f32_dpp v146, v146, v146 quad_perm:[2,3,0,1] row_mask:0xf bank_mask:0xf
    v_and_b32_dpp v8, v140, v3 quad_perm:[0,0,0,0] row_mask:0xf bank_mask:0xf
    v_and_b32_dpp v9, v140, v4 quad_perm:[0,0,0,0] row_mask:0xf bank_mask:0xf
    v_and_b32_dpp v10, v140, v3 quad_perm:[1,1,1,1] row_mask:0xf bank_mask:0xf
    v_and_b32_dpp v11, v140, v4 quad_perm:[1,1,1,1] row_mask:0xf bank_mask:0xf
    v_and_b32_dpp v12, v140, v3 quad_perm:[2,2,2,2] row_mask:0xf bank_mask:0xf
    v_and_b32_dpp v13, v140, v4 quad_perm:[2,2,2,2] row_mask:0xf bank_mask:0xf
    v_and_b32_dpp v14, v140, v3 quad_perm:[3,3,3,3] row_mask:0xf bank_mask:0xf
    v_and_b32_dpp v15, v140, v4 quad_perm:[3,3,3,3] row_mask:0xf bank_mask:0xf
    v_and_b32_dpp v16, v141, v3 quad_perm:[0,0,0,0] row_mask:0xf bank_mask:0xf
    v_and_b32_dpp v17, v141, v4 quad_perm:[0,0,0,0] row_mask:0xf bank_mask:0xf
    v_and_b32_dpp v18, v141, v3 quad_perm:[1,1,1,1] row_mask:0xf bank_mask:0xf
    v_and_b32_dpp v19, v141, v4 quad_perm:[1,1,1,1] row_mask:0xf bank_mask:0xf
    v_and_b32_dpp v20, v141, v3 quad_perm:[2,2,2,2] row_mask:0xf bank_mask:0xf
    v_and_b32_dpp v21, v141, v4 quad_perm:[2,2,2,2] row_mask:0xf bank_mask:0xf
    v_and_b32_dpp v22, v141, v3 quad_perm:[3,3,3,3] row_mask:0xf bank_mask:0xf
    v_and_b32_dpp v23, v141, v4 quad_perm:[3,3,3,3] row_mask:0xf bank_mask:0xf
    v_and_b32_dpp v24, v142, v3 quad_perm:[0,0,0,0] row_mask:0xf bank_mask:0xf
    v_and_b32_dpp v25, v142, v4 quad_perm:[0,0,0,0] row_mask:0xf bank_mask:0xf
    v_and_b32_dpp v26, v142, v3 quad_perm:[1,1,1,1] row_mask:0xf bank_mask:0xf
    v_and_b32_dpp v27, v142, v4 quad_perm:[1,1,1,1] row_mask:0xf bank_mask:0xf
    v_and_b32_dpp v28, v142, v3 quad_perm:[2,2,2,2] row_mask:0xf bank_mask:0xf
    v_and_b32_dpp v29, v142, v4 quad_perm:[2,2,2,2] row_mask:0xf bank_mask:0xf
    v_and_b32_dpp v30, v142, v3 quad_perm:[3,3,3,3] row_mask:0xf bank_mask:0xf
    v_and_b32_dpp v31, v142, v4 quad_perm:[3,3,3,3] row_mask:0xf bank_mask:0xf
    v_and_b32_dpp v32, v143, v3 quad_perm:[0,0,0,0] row_mask:0xf bank_mask:0xf
    v_and_b32_dpp v33, v143, v4 quad_perm:[0,0,0,0] row_mask:0xf bank_mask:0xf
    v_and_b32_dpp v34, v143, v3 quad_perm:[1,1,1,1] row_mask:0xf bank_mask:0xf
    v_and_b32_dpp v35, v143, v4 quad_perm:[1,1,1,1] row_mask:0xf bank_mask:0xf
    v_and_b32_dpp v36, v143, v3 quad_perm:[2,2,2,2] row_mask:0xf bank_mask:0xf
    v_and_b32_dpp v37, v143, v4 quad_perm:[2,2,2,2] row_mask:0xf bank_mask:0xf
    v_and_b32_dpp v38, v143, v3 quad_perm:[3,3,3,3] row_mask:0xf bank_mask:0xf
    v_and_b32_dpp v39, v143, v4 quad_perm:[3,3,3,3] row_mask:0xf bank_mask:0xf
    v_mov_b32 v7, v146
    s_nop 1
    v_permlane32_swap_b32 v146, v7
    v_add_f32 v146, v146, v7
    v_mov_b32 v7, v146
    s_nop 1
    v_permlane16_swap_b32 v146, v7
    v_add_f32 v146, v146, v7
    ds_write_b32 v144, v146 offset:192
    ds_read_b32 v50, v148 offset:64
    ds_read_b32 v51, v148 offset:192
    v_lshrrev_b32 v148, 2, v149
    s_cmp_eq_u32 s15, 0
    s_cbranch_scc1 L_pv
    buffer_load_dwordx4 v[72:75], v2, s[40:43], 0 offen offset:0 nt
    buffer_load_dwordx4 v[76:79], v2, s[40:43], 0 offen offset:1024 nt
    buffer_load_dwordx4 v[80:83], v2, s[40:43], 0 offen offset:2048 nt
    buffer_load_dwordx4 v[84:87], v2, s[40:43], 0 offen offset:3072 nt
    buffer_load_dwordx4 v[88:91], v2, s[40:43], s52 offen offset:0 nt
    buffer_load_dwordx4 v[92:95], v2, s[40:43], s52 offen offset:1024 nt
    buffer_load_dwordx4 v[96:99], v2, s[40:43], s52 offen offset:2048 nt
    buffer_load_dwordx4 v[100:103], v2, s[40:43], s52 offen offset:3072 nt
    buffer_load_dwordx4 v[104:107], v2, s[40:43], s53 offen offset:0 nt
    buffer_load_dwordx4 v[108:111], v2, s[40:43], s53 offen offset:1024 nt
    buffer_load_dwordx4 v[112:115], v2, s[40:43], s53 offen offset:2048 nt
    buffer_load_dwordx4 v[116:119], v2, s[40:43], s53 offen offset:3072 nt
    buffer_load_dwordx4 v[120:123], v2, s[40:43], s54 offen offset:0 nt
    buffer_load_dwordx4 v[124:127], v2, s[40:43], s54 offen offset:1024 nt
    buffer_load_dwordx4 v[128:131], v2, s[40:43], s54 offen offset:2048 nt
    buffer_load_dwordx4 v[132:135], v2, s[40:43], s54 offen offset:3072 nt
    s_mov_b64 exec, 1
    ds_add_u32 v5, v6 offset:32
    s_mov_b64 exec, -1
L_pv:
    s_waitcnt vmcnt(15)
    v_mfma_f32_16x16x16_bf16 v[152:155], v[8:9], v[72:73], 0
    v_mfma_f32_16x16x16_bf16 v[156:159], v[8:9], v[74:75], 0
    s_waitcnt vmcnt(14)
    v_mfma_f32_16x16x16_bf16 v[160:163], v[10:11], v[76:77], 0
    v_mfma_f32_16x16x16_bf16 v[164:167], v[10:11], v[78:79], 0
    s_waitcnt vmcnt(13)
    v_mfma_f32_16x16x16_bf16 v[152:155], v[12:13], v[80:81], v[152:155]
    v_mfma_f32_16x16x16_bf16 v[156:159], v[12:13], v[82:83], v[156:159]
    s_waitcnt vmcnt(12)
    v_mfma_f32_16x16x16_bf16 v[160:163], v[14:15], v[84:85], v[160:163]
    v_mfma_f32_16x16x16_bf16 v[164:167], v[14:15], v[86:87], v[164:167]
    s_waitcnt vmcnt(11)
    v_mfma_f32_16x16x16_bf16 v[152:155], v[16:17], v[88:89], v[152:155]
    v_mfma_f32_16x16x16_bf16 v[156:159], v[16:17], v[90:91], v[156:159]
    s_waitcnt vmcnt(10)
    v_mfma_f32_16x16x16_bf16 v[160:163], v[18:19], v[92:93], v[160:163]
    v_mfma_f32_16x16x16_bf16 v[164:167], v[18:19], v[94:95], v[164:167]
    s_waitcnt vmcnt(9)
    v_mfma_f32_16x16x16_bf16 v[152:155], v[20:21], v[96:97], v[152:155]
    v_mfma_f32_16x16x16_bf16 v[156:159], v[20:21], v[98:99], v[156:159]
    s_waitcnt vmcnt(8)
    v_mfma_f32_16x16x16_bf16 v[160:163], v[22:23], v[100:101], v[160:163]
    v_mfma_f32_16x16x16_bf16 v[164:167], v[22:23], v[102:103], v[164:167]
    s_waitcnt vmcnt(7)
    v_mfma_f32_16x16x16_bf16 v[152:155], v[24:25], v[104:105], v[152:155]
    v_mfma_f32_16x16x16_bf16 v[156:159], v[24:25], v[106:107], v[156:159]
    s_waitcnt vmcnt(6)
    v_mfma_f32_16x16x16_bf16 v[160:163], v[26:27], v[108:109], v[160:163]
    v_mfma_f32_16x16x16_bf16 v[164:167], v[26:27], v[110:111], v[164:167]
    s_waitcnt vmcnt(5)
    v_mfma_f32_16x16x16_bf16 v[152:155], v[28:29], v[112:113], v[152:155]
    v_mfma_f32_16x16x16_bf16 v[156:159], v[28:29], v[114:115], v[156:159]
    s_mov_b64 exec, 1
    ds_add_u32 v5, v6 offset:52
    s_mov_b64 exec, -1
    ds_read_b32 v60, v5 offset:12
    s_waitcnt vmcnt(4)
    v_mfma_f32_16x16x16_bf16 v[160:163], v[30:31], v[116:117], v[160:163]
    v_mfma_f32_16x16x16_bf16 v[164:167], v[30:31], v[118:119], v[164:167]
    s_waitcnt lgkmcnt(0)
    v_readfirstlane_b32 s63, v60
    s_cmp_eq_u32 s63, 7
    s_cbranch_scc1 L_fast11
    s_waitcnt vmcnt(3)
    v_mfma_f32_16x16x16_bf16 v[152:155], v[32:33], v[120:121], v[152:155]
    v_mfma_f32_16x16x16_bf16 v[156:159], v[32:33], v[122:123], v[156:159]
    ds_read_b32 v60, v5 offset:12
    s_waitcnt vmcnt(2)
    v_mfma_f32_16x16x16_bf16 v[160:163], v[34:35], v[124:125], v[160:163]
    v_mfma_f32_16x16x16_bf16 v[164:167], v[34:35], v[126:127], v[164:167]
    s_waitcnt lgkmcnt(0)
    v_readfirstlane_b32 s63, v60
    s_cmp_eq_u32 s63, 7
    s_cbranch_scc1 L_fast13
    s_mov_b64 exec, 1
    ds_add_rtn_u32 v7, v5, v6 offset:44
    s_mov_b64 exec, -1
    s_waitcnt vmcnt(1)
    v_mfma_f32_16x16x16_bf16 v[152:155], v[36:37], v[128:129], v[152:155]
    v_mfma_f32_16x16x16_bf16 v[156:159], v[36:37], v[130:131], v[156:159]
    s_waitcnt lgkmcnt(0)
    v_readfirstlane_b32 s55, v7
    s_cmp_eq_u32 s55, 0
    s_cbranch_scc1 L_first
    s_sub_u32 s50, s55, 1
    s_lshl_b32 s51, s50, 11
    s_lshl_b32 s50, s50, 5
    v_add_u32 v54, s51, v150
    v_add_u32 v55, s50, v148
    v_add_u32 v55, 65536, v55
    ds_read_b32 v60, v5 offset:12
    ds_read_b128 v[40:43], v54
    ds_read_b128 v[44:47], v54 offset:1024
    ds_read_b64 v[48:49], v55 offset:14336
    s_waitcnt vmcnt(0)
    v_mfma_f32_16x16x16_bf16 v[160:163], v[38:39], v[132:133], v[160:163]
    v_mfma_f32_16x16x16_bf16 v[164:167], v[38:39], v[134:135], v[164:167]
    s_waitcnt lgkmcnt(0)
    v_cmp_le_u32 vcc, s55, v60
    s_cbranch_vccnz L_prevok
    s_mov_b32 s64, 262144
L_spin_30:
    ds_read_b32 v7, v5 offset:12
    ds_read_b128 v[40:43], v54
    ds_read_b128 v[44:47], v54 offset:1024
    ds_read_b64 v[48:49], v55 offset:14336
    s_waitcnt lgkmcnt(0)
    v_cmp_le_u32 vcc, s55, v7
    s_cbranch_vccnz L_spun_31
    s_sub_u32 s64, s64, 1
    s_cmp_lg_u32 s64, 0
    s_cbranch_scc1 L_spin_30
L_spun_31:
L_prevok:
    v_max_f32 v62, v48, v50
    v_sub_f32 v58, v48, v62
    v_sub_f32 v59, v50, v62
    v_mul_f32 v58, 0x3fb8aa3b, v58
    v_mul_f32 v59, 0x3fb8aa3b, v59
    v_exp_f32 v58, v58
    v_exp_f32 v59, v59
    s_nop 0
    v_pk_mul_f32 v[40:41], v[40:41], v[58:59] op_sel:[0,0] op_sel_hi:[1,0]
    v_pk_mul_f32 v[42:43], v[42:43], v[58:59] op_sel:[0,0] op_sel_hi:[1,0]
    v_pk_mul_f32 v[44:45], v[44:45], v[58:59] op_sel:[0,0] op_sel_hi:[1,0]
    v_pk_mul_f32 v[46:47], v[46:47], v[58:59] op_sel:[0,0] op_sel_hi:[1,0]
    v_mul_f32 v61, v49, v58
    v_fmac_f32 v61, v51, v59
    v_pk_fma_f32 v[40:41], v[152:153], v[58:59], v[40:41] op_sel:[0,1,0] op_sel_hi:[1,1,1]
    v_pk_fma_f32 v[42:43], v[154:155], v[58:59], v[42:43] op_sel:[0,1,0] op_sel_hi:[1,1,1]
    v_pk_fma_f32 v[44:45], v[156:157], v[58:59], v[44:45] op_sel:[0,1,0] op_sel_hi:[1,1,1]
    v_pk_fma_f32 v[46:47], v[158:159], v[58:59], v[46:47] op_sel:[0,1,0] op_sel_hi:[1,1,1]
    v_pk_fma_f32 v[40:41], v[160:161], v[58:59], v[40:41] op_sel:[0,1,0] op_sel_hi:[1,1,1]
    v_pk_fma_f32 v[42:43], v[162:163], v[58:59], v[42:43] op_sel:[0,1,0] op_sel_hi:[1,1,1]
    v_pk_fma_f32 v[44:45], v[164:165], v[58:59], v[44:45] op_sel:[0,1,0] op_sel_hi:[1,1,1]
    v_pk_fma_f32 v[46:47], v[166:167], v[58:59], v[46:47] op_sel:[0,1,0] op_sel_hi:[1,1,1]
    s_cmp_eq_u32 s55, 7
    s_cbranch_scc1 L_final
    s_branch L_pub
L_first:
    s_waitcnt vmcnt(0)
    v_mfma_f32_16x16x16_bf16 v[160:163], v[38:39], v[132:133], v[160:163]
    v_mfma_f32_16x16x16_bf16 v[164:167], v[38:39], v[134:135], v[164:167]
    s_sub_u32 s50, s55, 1
    v_mov_b32 v62, v50
    v_mov_b32 v61, v51
    v_add_u32 v54, 0xfffff800, v150
    v_add_u32 v55, 65504, v148
    s_nop 1
    v_add_f32 v40, v152, v160
    v_add_f32 v41, v153, v161
    v_add_f32 v42, v154, v162
    v_add_f32 v43, v155, v163
    v_add_f32 v44, v156, v164
    v_add_f32 v45, v157, v165
    v_add_f32 v46, v158, v166
    v_add_f32 v47, v159, v167
L_pub:
    v_mov_b32 v48, v62
    v_mov_b32 v49, v61
    ds_write_b128 v54, v[40:43] offset:2048
    ds_write_b128 v54, v[44:47] offset:3072
    ds_write_b64 v55, v[48:49] offset:14368
    s_mov_b64 exec, 1
    ds_add_u32 v5, v6 offset:12
    s_mov_b64 exec, -1
    s_branch L_jobs
L_fast11:
    v_add_u32 v55, 65536, v148
    ds_read_b128 v[40:43], v150 offset:12288
    ds_read_b128 v[44:47], v150 offset:13312
    ds_read_b64 v[48:49], v55 offset:14528
    s_waitcnt vmcnt(3)
    v_mfma_f32_16x16x16_bf16 v[152:155], v[32:33], v[120:121], v[152:155]
    v_mfma_f32_16x16x16_bf16 v[156:159], v[32:33], v[122:123], v[156:159]
    s_waitcnt lgkmcnt(0)
    v_max_f32 v62, v48, v50
    v_sub_f32 v58, v48, v62
    v_sub_f32 v59, v50, v62
    v_mul_f32 v58, 0x3fb8aa3b, v58
    v_mul_f32 v59, 0x3fb8aa3b, v59
    v_exp_f32 v58, v58
    v_exp_f32 v59, v59
    s_nop 0
    v_pk_mul_f32 v[40:41], v[40:41], v[58:59] op_sel:[0,0] op_sel_hi:[1,0]
    v_pk_mul_f32 v[42:43], v[42:43], v[58:59] op_sel:[0,0] op_sel_hi:[1,0]
    v_pk_mul_f32 v[44:45], v[44:45], v[58:59] op_sel:[0,0] op_sel_hi:[1,0]
    v_pk_mul_f32 v[46:47], v[46:47], v[58:59] op_sel:[0,0] op_sel_hi:[1,0]
    v_mul_f32 v61, v49, v58
    v_fmac_f32 v61, v51, v59
    s_waitcnt vmcnt(2)
    v_mfma_f32_16x16x16_bf16 v[160:163], v[34:35], v[124:125], v[160:163]
    v_mfma_f32_16x16x16_bf16 v[164:167], v[34:35], v[126:127], v[164:167]
    s_waitcnt vmcnt(1)
    v_mfma_f32_16x16x16_bf16 v[152:155], v[36:37], v[128:129], v[152:155]
    v_mfma_f32_16x16x16_bf16 v[156:159], v[36:37], v[130:131], v[156:159]
    s_nop 6
    v_pk_fma_f32 v[40:41], v[152:153], v[58:59], v[40:41] op_sel:[0,1,0] op_sel_hi:[1,1,1]
    v_pk_fma_f32 v[42:43], v[154:155], v[58:59], v[42:43] op_sel:[0,1,0] op_sel_hi:[1,1,1]
    v_pk_fma_f32 v[44:45], v[156:157], v[58:59], v[44:45] op_sel:[0,1,0] op_sel_hi:[1,1,1]
    v_pk_fma_f32 v[46:47], v[158:159], v[58:59], v[46:47] op_sel:[0,1,0] op_sel_hi:[1,1,1]
    s_waitcnt vmcnt(0)
    v_mfma_f32_16x16x16_bf16 v[160:163], v[38:39], v[132:133], v[160:163]
    v_mfma_f32_16x16x16_bf16 v[164:167], v[38:39], v[134:135], v[164:167]
    s_nop 6
    v_pk_fma_f32 v[40:41], v[160:161], v[58:59], v[40:41] op_sel:[0,1,0] op_sel_hi:[1,1,1]
    v_pk_fma_f32 v[42:43], v[162:163], v[58:59], v[42:43] op_sel:[0,1,0] op_sel_hi:[1,1,1]
    v_pk_fma_f32 v[44:45], v[164:165], v[58:59], v[44:45] op_sel:[0,1,0] op_sel_hi:[1,1,1]
    v_pk_fma_f32 v[46:47], v[166:167], v[58:59], v[46:47] op_sel:[0,1,0] op_sel_hi:[1,1,1]
    s_branch L_final
L_fast13:
    v_add_u32 v55, 65536, v148
    ds_read_b128 v[40:43], v150 offset:12288
    ds_read_b128 v[44:47], v150 offset:13312
    ds_read_b64 v[48:49], v55 offset:14528
    s_waitcnt lgkmcnt(0)
    v_max_f32 v62, v48, v50
    v_sub_f32 v58, v48, v62
    v_sub_f32 v59, v50, v62
    v_mul_f32 v58, 0x3fb8aa3b, v58
    v_mul_f32 v59, 0x3fb8aa3b, v59
    v_exp_f32 v58, v58
    v_exp_f32 v59, v59
    s_nop 0
    v_pk_mul_f32 v[40:41], v[40:41], v[58:59] op_sel:[0,0] op_sel_hi:[1,0]
    v_pk_mul_f32 v[42:43], v[42:43], v[58:59] op_sel:[0,0] op_sel_hi:[1,0]
    v_pk_mul_f32 v[44:45], v[44:45], v[58:59] op_sel:[0,0] op_sel_hi:[1,0]
    v_pk_mul_f32 v[46:47], v[46:47], v[58:59] op_sel:[0,0] op_sel_hi:[1,0]
    v_mul_f32 v61, v49, v58
    v_fmac_f32 v61, v51, v59
    s_waitcnt vmcnt(1)
    v_mfma_f32_16x16x16_bf16 v[152:155], v[36:37], v[128:129], v[152:155]
    v_mfma_f32_16x16x16_bf16 v[156:159], v[36:37], v[130:131], v[156:159]
    s_nop 6
    v_pk_fma_f32 v[40:41], v[152:153], v[58:59], v[40:41] op_sel:[0,1,0] op_sel_hi:[1,1,1]
    v_pk_fma_f32 v[42:43], v[154:155], v[58:59], v[42:43] op_sel:[0,1,0] op_sel_hi:[1,1,1]
    v_pk_fma_f32 v[44:45], v[156:157], v[58:59], v[44:45] op_sel:[0,1,0] op_sel_hi:[1,1,1]
    v_pk_fma_f32 v[46:47], v[158:159], v[58:59], v[46:47] op_sel:[0,1,0] op_sel_hi:[1,1,1]
    s_waitcnt vmcnt(0)
    v_mfma_f32_16x16x16_bf16 v[160:163], v[38:39], v[132:133], v[160:163]
    v_mfma_f32_16x16x16_bf16 v[164:167], v[38:39], v[134:135], v[164:167]
    s_nop 6
    v_pk_fma_f32 v[40:41], v[160:161], v[58:59], v[40:41] op_sel:[0,1,0] op_sel_hi:[1,1,1]
    v_pk_fma_f32 v[42:43], v[162:163], v[58:59], v[42:43] op_sel:[0,1,0] op_sel_hi:[1,1,1]
    v_pk_fma_f32 v[44:45], v[164:165], v[58:59], v[44:45] op_sel:[0,1,0] op_sel_hi:[1,1,1]
    v_pk_fma_f32 v[46:47], v[166:167], v[58:59], v[46:47] op_sel:[0,1,0] op_sel_hi:[1,1,1]
L_final:
    s_lshl_b32 s50, s2, 11
    s_add_u32 s50, s50, 1048576
    v_mov_b32 v138, s31
    s_mov_b32 s52, 0xfff
    v_add_u32 v40, 0x800, v40
    v_add_u32 v41, 0x800, v41
    v_add_u32 v42, 0x800, v42
    v_add_u32 v43, 0x800, v43
    v_add_u32 v44, 0x800, v44
    v_add_u32 v45, 0x800, v45
    v_add_u32 v46, 0x800, v46
    v_add_u32 v47, 0x800, v47
    v_bfi_b32 v40, s52, v138, v40
    v_bfi_b32 v41, s52, v138, v41
    v_bfi_b32 v42, s52, v138, v42
    v_bfi_b32 v43, s52, v138, v43
    v_bfi_b32 v44, s52, v138, v44
    v_bfi_b32 v45, s52, v138, v45
    v_bfi_b32 v46, s52, v138, v46
    v_bfi_b32 v47, s52, v138, v47
    buffer_store_dwordx4 v[40:43], v2, s[32:35], s50 offen sc1
    buffer_store_dwordx4 v[44:47], v2, s[32:35], s50 offen offset:1024 sc1
    s_lshr_b32 s50, s29, 3
    s_lshl_b32 s50, s50, 3
    s_add_u32 s50, s50, s28
    s_lshl_b32 s50, s50, 8
    s_and_b32 s51, s29, 3
    s_lshl_b32 s51, s51, 4
    s_add_u32 s50, s50, s51
    s_bfe_u32 s51, s29, 0x10002
    s_lshl_b32 s51, s51, 3
    s_add_u32 s50, s50, s51
    s_add_u32 s50, s50, 1572864
    v_lshlrev_b32 v137, 1, v149
    v_or_b32 v52, v62, v138
    v_mov_b32 v53, v61
    v_add_u32 v53, 0x800, v53
    v_bfi_b32 v53, s52, v138, v53
    s_mov_b32 exec_lo, 0x00010001
    s_mov_b32 exec_hi, 0x00010001
    buffer_store_dwordx2 v[52:53], v137, s[32:35], s50 offen sc1
    s_mov_b64 exec, -1
    s_mov_b64 exec, 1
    ds_add_u32 v5, v6 offset:12
    s_mov_b64 exec, -1
    s_branch L_sdone
L_jobs:
    s_cmp_eq_u32 s55, 1
    s_cbranch_scc1 L_gjob
    s_cmp_lg_u32 s55, 0
    s_cbranch_scc1 L_sdone
    s_cmp_ge_u32 s29, 28
    s_cbranch_scc1 L_sdone
    v_and_b32 v8, 3, v0
    v_lshrrev_b32 v9, 4, v0
    v_bfe_u32 v10, v0, 2, 2
    v_mov_b32 v11, s31
    s_mov_b32 s66, 0xfff
    s_mov_b32 s94, 0x00f000f0
    s_mov_b32 s95, 0x00f000f0
    s_mov_b32 s96, 0x0f000f00
    s_mov_b32 s97, 0x0f000f00
    s_mov_b32 s98, 0xf000f000
    s_mov_b32 s99, 0xf000f000
    v_lshlrev_b32 v7, 3, v8
    v_lshl_add_u32 v7, v10, 6, v7
    s_movk_i32 s50, 2080
    v_mad_u32_u24 v12, v9, s50, v7
    s_mov_b32 s36, s20
    s_mov_b32 s37, s21
    s_mov_b32 s38, 1835008
    s_mov_b32 s39, 0x00020000
    v_lshlrev_b32 v13, 4, v8
    v_lshl_add_u32 v13, v9, 6, v13
    v_lshl_add_u32 v13, v10, 10, v13
    s_lshr_b32 s50, s48, 2
    s_lshl_b32 s50, s50, 15
    s_and_b32 s51, s48, 3
    s_lshl_b32 s51, s51, 8
    s_add_u32 s50, s50, s51
    s_mov_b32 s64, 262144
L_spin_32:
    ds_read_b32 v7, v5 offset:32
    s_waitcnt lgkmcnt(0)
    v_cmp_le_u32 vcc, 8, v7
    s_cbranch_vccnz L_spun_33
    s_sleep 2
    s_sub_u32 s64, s64, 1
    s_cmp_lg_u32 s64, 0
    s_cbranch_scc1 L_spin_32
L_spun_33:
    s_mov_b32 m0, 35840
    s_nop 0
    buffer_load_dwordx4 v13, s[36:39], s50 offen nt lds
    s_mov_b32 m0, 36880
    s_add_u32 s50, s50, 4096
    buffer_load_dwordx4 v13, s[36:39], s50 offen nt lds
    s_mov_b32 m0, 37920
    s_add_u32 s50, s50, 4096
    buffer_load_dwordx4 v13, s[36:39], s50 offen nt lds
    s_mov_b32 m0, 38960
    s_add_u32 s50, s50, 4096
    buffer_load_dwordx4 v13, s[36:39], s50 offen nt lds
    s_mov_b32 m0, 40000
    s_add_u32 s50, s50, 4096
    buffer_load_dwordx4 v13, s[36:39], s50 offen nt lds
    s_mov_b32 m0, 41040
    s_add_u32 s50, s50, 4096
    buffer_load_dwordx4 v13, s[36:39], s50 offen nt lds
    s_mov_b32 m0, 42080
    s_add_u32 s50, s50, 4096
    buffer_load_dwordx4 v13, s[36:39], s50 offen nt lds
    s_mov_b32 m0, 43120
    s_add_u32 s50, s50, 4096
    buffer_load_dwordx4 v13, s[36:39], s50 offen nt lds
    v_lshlrev_b32 v14, 4, v0
    s_mov_b32 s64, 262144
L_spin_34:
    ds_read_b32 v7, v5 offset:24
    ds_read_b128 v[48:51], v14 offset:18944
    s_waitcnt lgkmcnt(0)
    v_cmp_le_u32 vcc, 1, v7
    s_cbranch_vccnz L_spun_35
    s_sleep 2
    s_sub_u32 s64, s64, 1
    s_cmp_lg_u32 s64, 0
    s_cbranch_scc1 L_spin_34
L_spun_35:
    s_waitcnt vmcnt(0)
    ds_read_b64_tr_b16 v[16:17], v12 offset:35840
    ds_read_b64_tr_b16 v[18:19], v12 offset:36880
    ds_read_b64_tr_b16 v[20:21], v12 offset:35872
    ds_read_b64_tr_b16 v[22:23], v12 offset:36912
    ds_read_b64_tr_b16 v[24:25], v12 offset:36096
    ds_read_b64_tr_b16 v[26:27], v12 offset:37136
    ds_read_b64_tr_b16 v[28:29], v12 offset:36128
    ds_read_b64_tr_b16 v[30:31], v12 offset:37168
    ds_read_b64_tr_b16 v[32:33], v12 offset:36352
    ds_read_b64_tr_b16 v[34:35], v12 offset:37392
    ds_read_b64_tr_b16 v[36:37], v12 offset:36384
    ds_read_b64_tr_b16 v[38:39], v12 offset:37424
    ds_read_b64_tr_b16 v[40:41], v12 offset:36608
    ds_read_b64_tr_b16 v[42:43], v12 offset:37648
    ds_read_b64_tr_b16 v[44:45], v12 offset:36640
    ds_read_b64_tr_b16 v[46:47], v12 offset:37680
    v_lshlrev_b32 v13, 6, v8
    v_lshl_add_u32 v13, v9, 4, v13
    v_lshl_add_u32 v13, v10, 8, v13
    s_lshl_b32 s50, s48, 11
    s_add_u32 s50, s50, 2621440
    s_waitcnt lgkmcnt(14)
    v_mfma_f32_16x16x32_bf16 v[96:99], v[16:19], v[48:51], 0
    s_waitcnt lgkmcnt(12)
    v_mfma_f32_16x16x32_bf16 v[100:103], v[20:23], v[48:51], 0
    s_waitcnt lgkmcnt(10)
    v_mfma_f32_16x16x32_bf16 v[104:107], v[24:27], v[48:51], 0
    s_waitcnt lgkmcnt(8)
    v_mfma_f32_16x16x32_bf16 v[108:111], v[28:31], v[48:51], 0
    s_waitcnt lgkmcnt(6)
    v_mfma_f32_16x16x32_bf16 v[112:115], v[32:35], v[48:51], 0
    s_waitcnt lgkmcnt(4)
    v_mfma_f32_16x16x32_bf16 v[116:119], v[36:39], v[48:51], 0
    s_waitcnt lgkmcnt(2)
    v_mfma_f32_16x16x32_bf16 v[120:123], v[40:43], v[48:51], 0
    s_waitcnt lgkmcnt(0)
    v_mfma_f32_16x16x32_bf16 v[124:127], v[44:47], v[48:51], 0
    v_cndmask_b32 v16, v96, v100, s[94:95]
    v_cndmask_b32 v17, v97, v101, s[94:95]
    v_cndmask_b32 v18, v98, v102, s[94:95]
    v_cndmask_b32 v19, v99, v103, s[94:95]
    v_cndmask_b32 v16, v16, v104, s[96:97]
    v_cndmask_b32 v17, v17, v105, s[96:97]
    v_cndmask_b32 v18, v18, v106, s[96:97]
    v_cndmask_b32 v19, v19, v107, s[96:97]
    v_cndmask_b32 v16, v16, v108, s[98:99]
    v_cndmask_b32 v17, v17, v109, s[98:99]
    v_cndmask_b32 v18, v18, v110, s[98:99]
    v_cndmask_b32 v19, v19, v111, s[98:99]
    v_cndmask_b32 v20, v112, v116, s[94:95]
    v_cndmask_b32 v21, v113, v117, s[94:95]
    v_cndmask_b32 v22, v114, v118, s[94:95]
    v_cndmask_b32 v23, v115, v119, s[94:95]
    v_cndmask_b32 v20, v20, v120, s[96:97]
    v_cndmask_b32 v21, v21, v121, s[96:97]
    v_cndmask_b32 v22, v22, v122, s[96:97]
    v_cndmask_b32 v23, v23, v123, s[96:97]
    v_cndmask_b32 v20, v20, v124, s[98:99]
    v_cndmask_b32 v21, v21, v125, s[98:99]
    v_cndmask_b32 v22, v22, v126, s[98:99]
    v_cndmask_b32 v23, v23, v127, s[98:99]
    v_add_u32 v16, 0x800, v16
    v_add_u32 v17, 0x800, v17
    v_add_u32 v18, 0x800, v18
    v_add_u32 v19, 0x800, v19
    v_add_u32 v20, 0x800, v20
    v_add_u32 v21, 0x800, v21
    v_add_u32 v22, 0x800, v22
    v_add_u32 v23, 0x800, v23
    v_bfi_b32 v16, s66, v11, v16
    v_bfi_b32 v17, s66, v11, v17
    v_bfi_b32 v18, s66, v11, v18
    v_bfi_b32 v19, s66, v11, v19
    v_bfi_b32 v20, s66, v11, v20
    v_bfi_b32 v21, s66, v11, v21
    v_bfi_b32 v22, s66, v11, v22
    v_bfi_b32 v23, s66, v11, v23
    buffer_store_dwordx4 v[16:19], v13, s[32:35], s50 offen offset:0 sc1
    buffer_store_dwordx4 v[20:23], v13, s[32:35], s50 offen offset:1024 sc1
    s_branch L_sdone
L_gjob:
    s_cmp_ge_u32 s2, 64
    s_cbranch_scc1 L_sdone
    v_lshrrev_b32 v7, 3, v0
    v_lshlrev_b32 v12, 13, v7
    v_and_b32 v7, 7, v0
    v_lshl_add_u32 v12, v7, 4, v12
    s_lshr_b32 s50, s101, 1
    s_lshl_b32 s50, s50, 8
    s_and_b32 s51, s101, 1
    s_lshl_b32 s51, s51, 7
    s_add_u32 s50, s50, s51
    v_add_u32 v12, s50, v12
    s_mov_b32 s56, 2621440
    s_mov_b32 s57, 2686976
    s_mov_b32 s58, 2752512
    s_mov_b32 s59, 2818048
    s_mov_b32 s60, 2883584
    s_mov_b32 s61, 2949120
    s_mov_b32 s62, 3014656
    s_mov_b32 s64, 262144
L_spin_36:
    ds_read_b32 v7, v5 offset:12
    s_waitcnt lgkmcnt(0)
    v_cmp_le_u32 vcc, 8, v7
    s_cbranch_vccnz L_spun_37
    s_sleep 4
    s_sub_u32 s64, s64, 1
    s_cmp_lg_u32 s64, 0
    s_cbranch_scc1 L_spin_36
L_spun_37:
    s_mov_b32 s64, 16384
L_poll_38:
    buffer_load_dwordx4 v[16:19], v12, s[32:35], s56 offen sc1
    buffer_load_dwordx4 v[20:23], v12, s[32:35], s57 offen sc1
    buffer_load_dwordx4 v[24:27], v12, s[32:35], s58 offen sc1
    buffer_load_dwordx4 v[28:31], v12, s[32:35], s59 offen sc1
    buffer_load_dwordx4 v[32:35], v12, s[32:35], s60 offen sc1
    buffer_load_dwordx4 v[36:39], v12, s[32:35], s61 offen sc1
    buffer_load_dwordx4 v[40:43], v12, s[32:35], s62 offen sc1
    s_waitcnt vmcnt(0)
    v_xor_b32 v16, s31, v16
    v_xor_b32 v17, s31, v17
    v_xor_b32 v18, s31, v18
    v_xor_b32 v19, s31, v19
    v_xor_b32 v20, s31, v20
    v_xor_b32 v21, s31, v21
    v_xor_b32 v22, s31, v22
    v_xor_b32 v23, s31, v23
    v_xor_b32 v24, s31, v24
    v_xor_b32 v25, s31, v25
    v_xor_b32 v26, s31, v26
    v_xor_b32 v27, s31, v27
    v_xor_b32 v28, s31, v28
    v_xor_b32 v29, s31, v29
    v_xor_b32 v30, s31, v30
    v_xor_b32 v31, s31, v31
    v_xor_b32 v32, s31, v32
    v_xor_b32 v33, s31, v33
    v_xor_b32 v34, s31, v34
    v_xor_b32 v35, s31, v35
    v_xor_b32 v36, s31, v36
    v_xor_b32 v37, s31, v37
    v_xor_b32 v38, s31, v38
    v_xor_b32 v39, s31, v39
    v_xor_b32 v40, s31, v40
    v_xor_b32 v41, s31, v41
    v_xor_b32 v42, s31, v42
    v_xor_b32 v43, s31, v43
    v_or3_b32 v7, v16, v17, v18
    v_or3_b32 v7, v7, v19, v20
    v_or3_b32 v7, v7, v21, v22
    v_or3_b32 v7, v7, v23, v24
    v_or3_b32 v7, v7, v25, v26
    v_or3_b32 v7, v7, v27, v28
    v_or3_b32 v7, v7, v29, v30
    v_or3_b32 v7, v7, v31, v32
    v_or3_b32 v7, v7, v33, v34
    v_or3_b32 v7, v7, v35, v36
    v_or3_b32 v7, v7, v37, v38
    v_or3_b32 v7, v7, v39, v40
    v_or3_b32 v7, v7, v41, v42
    v_or_b32 v7, v7, v43
    v_and_b32 v7, 0xfff, v7
    v_cmp_ne_u32 vcc, 0, v7
    s_and_b64 exec, vcc, vcc
    s_cbranch_scc0 L_polled_39
    s_sleep 4
    s_sub_u32 s64, s64, 1
    s_cmp_lg_u32 s64, 0
    s_cbranch_scc1 L_poll_38
L_polled_39:
    s_mov_b64 exec, -1
    v_add_f32 v16, v16, v32
    v_add_f32 v17, v17, v33
    v_add_f32 v18, v18, v34
    v_add_f32 v19, v19, v35
    v_add_f32 v20, v20, v36
    v_add_f32 v21, v21, v37
    v_add_f32 v22, v22, v38
    v_add_f32 v23, v23, v39
    v_add_f32 v24, v24, v40
    v_add_f32 v25, v25, v41
    v_add_f32 v26, v26, v42
    v_add_f32 v27, v27, v43
    v_add_f32 v16, v16, v24
    v_add_f32 v17, v17, v25
    v_add_f32 v18, v18, v26
    v_add_f32 v19, v19, v27
    v_add_f32 v20, v20, v28
    v_add_f32 v21, v21, v29
    v_add_f32 v22, v22, v30
    v_add_f32 v23, v23, v31
    v_add_f32 v16, v16, v20
    v_add_f32 v17, v17, v21
    v_add_f32 v18, v18, v22
    v_add_f32 v19, v19, v23
    v_permlane32_swap_b32 v16, v17
    s_nop 0
    v_permlane32_swap_b32 v18, v19
    v_add_f32 v16, v16, v17
    v_add_f32 v18, v18, v19
    s_nop 1
    v_permlane16_swap_b32 v16, v18
    v_add_f32 v16, v16, v18
    s_nop 1
    v_add_f32_dpp v16, v16, v16 row_ror:8 row_mask:0xf bank_mask:0xf
    v_cvt_pk_bf16_f32 v16, v16, v16
    v_and_b32 v16, 0xffff0000, v16
    v_mul_f32 v17, 0xbfb8aa3b, v16
    v_exp_f32 v17, v17
    s_nop 0
    v_add_f32 v17, 1.0, v17
    v_rcp_f32 v17, v17
    s_nop 0
    v_mul_f32 v16, v16, v17
    v_cvt_pk_bf16_f32 v16, v16, v16
    v_and_b32 v16, 0xffff0000, v16
    v_lshlrev_b32 v17, 2, v0
    ds_write_b32 v17, v16 offset:65152
    s_mov_b64 exec, 1
    ds_add_u32 v5, v6 offset:36
    s_mov_b64 exec, -1
L_sdone:
    s_endpgm
.section .rodata,"a"
.p2align 6
.amdhsa_kernel recurrent_scan__gqa_block_cached__glu_gated_swiglu__decode_kernel
  .amdhsa_next_free_vgpr 168
  .amdhsa_next_free_sgpr 102
  .amdhsa_accum_offset 168
  .amdhsa_group_segment_fixed_size 0
  .amdhsa_kernarg_size 96
  .amdhsa_user_sgpr_count 2
  .amdhsa_user_sgpr_kernarg_segment_ptr 1
  .amdhsa_system_sgpr_workgroup_id_x 1
.end_amdhsa_kernel
```
